```python
import torch

def _softmax(x, axis=-1):
    return torch.softmax(x, dim=axis)
def _gelu(x):
    return torch.nn.functional.gelu(x, approximate="tanh")
def _silu(x):
    return torch.nn.functional.silu(x)
def _sigmoid(x):
    return torch.sigmoid(x)
def _layernorm(x, axis=-1, eps=1e-5):
    m = x.mean(dim=axis, keepdim=True)
    v = x.var(dim=axis, keepdim=True, unbiased=False)
    return (x - m) / torch.sqrt(v + eps)
def _scatter_add(tgt, idx, src, axis=0):
    return tgt.clone().index_add_(axis, idx, src)
def _segment_sum(src, seg, n):
    out = torch.zeros((n,) + src.shape[1:], dtype=src.dtype)
    return out.index_add_(0, seg, src)
def _pad(x, pw):
    flat = tuple(v for pair in reversed(pw) for v in pair)
    return torch.nn.functional.pad(x, flat)

kernel_name = 'standalone__gqa_softmax__sampling'

def setup_inputs():

    _w = (lambda a: (lambda t: t.to(torch.bfloat16) if t.is_floating_point() else t)(torch.as_tensor(a)))
    B, Hq, Hkv, Sq, Sk, D = 8, 32, 8, 16, 8192, 128
    return {
        "q": _w((lambda *s: torch.randn(*s, dtype=torch.bfloat16) * 0.8)(B, Hq, Sq, D)),
        "k": _w((lambda *s: torch.randn(*s, dtype=torch.bfloat16) * 0.8)(B, Hkv, Sk, D)),
        "v": _w((lambda *s: torch.randn(*s, dtype=torch.bfloat16) * 0.05)(B, Hkv, Sk, D)),
    }

def reference(q, k, v):
    B, Hq, Sq, D = q.shape
    Hkv = k.shape[1]
    rep = Hq // Hkv
    k = (lambda x, n, axis: torch.repeat_interleave(x, n, dim=axis))(k, rep, axis=1)
    v = (lambda x, n, axis: torch.repeat_interleave(x, n, dim=axis))(v, rep, axis=1)
    scale = D ** -0.5
    scores = torch.einsum("bhqd,bhkd->bhqk", q, k) * scale
    p = _softmax(scores, axis=-1)
    return torch.einsum("bhqk,bhkd->bhqd", p, v)
```

```asm
; @launch grid=(256,1,1) block=(320,1,1) lds=82048
.amdgcn_target "amdgcn-amd-amdhsa--gfx950"
.text
.globl standalone__gqa_softmax__sampling_kernel
.p2align 8
.type standalone__gqa_softmax__sampling_kernel,@function
standalone__gqa_softmax__sampling_kernel:
    s_cmp_ge_u32 s2, 256
    s_cbranch_scc1 L_done
    s_load_dwordx4 s[4:7], s[0:1], 0
    s_load_dwordx4 s[8:11], s[0:1], 16
    s_load_dwordx4 s[12:15], s[0:1], 32

    v_lshrrev_b32 v2, 6, v0
    v_and_b32 v3, 63, v0
    v_readfirstlane_b32 s24, v2

    s_and_b32 s26, s2, 7
    s_lshr_b32 s27, s26, 1
    s_xor_b32 s26, s26, s27
    s_and_b32 s26, s26, 1
    s_lshr_b32 s25, s2, 3
    s_lshl_b32 s25, s25, 1
    s_or_b32 s25, s25, s26
    s_mov_b32 s26, s27

    s_cmp_lt_u32 s24, 4
    s_cbranch_scc1 L_comp

    s_lshl_b32 s29, s25, 21
    v_lshrrev_b32 v4, 4, v3
    v_and_b32 v5, 15, v3
    v_lshlrev_b32 v6, 1, v4
    v_xor_b32 v5, v5, v6
    v_lshlrev_b32 v5, 4, v5
    v_and_b32 v6, 1, v4
    v_lshl_add_u32 v5, v6, 8, v5
    v_lshrrev_b32 v6, 1, v4
    v_lshl_add_u32 v1, v6, 9, v5
    v_xor_b32 v2, 0x80, v1
    s_mov_b32 s31, 0
    s_mul_i32 s46, s26, 58

    s_mov_b32 s49, 0x7fffffff
    s_mov_b32 s55, 0
    v_mov_b32 v21, s49
    v_mov_b32 v22, 65536
    v_mov_b32 v23, 0
    v_mov_b32 v24, 1
    v_mov_b32 v20, 0
    ds_write_b32 v22, v21

    s_add_u32 s32, s46, 0
    s_bfe_u32 s52, s32, 0x20000
    s_lshl_b32 s52, s52, 10
    s_bfe_u32 s53, s32, 0x60002
    s_lshl_b32 s53, s53, 15
    s_add_u32 s52, s52, s53
    s_mov_b32 s32, s52
    s_mov_b32 s56, s32
    s_add_u32 s32, s46, 1
    s_bfe_u32 s52, s32, 0x20000
    s_lshl_b32 s52, s52, 10
    s_bfe_u32 s53, s32, 0x60002
    s_lshl_b32 s53, s53, 15
    s_add_u32 s52, s52, s53
    s_mov_b32 s32, s52
    s_mov_b32 s57, s32
    s_add_u32 s32, s46, 2
    s_bfe_u32 s52, s32, 0x20000
    s_lshl_b32 s52, s52, 10
    s_bfe_u32 s53, s32, 0x60002
    s_lshl_b32 s53, s53, 15
    s_add_u32 s52, s52, s53
    s_mov_b32 s32, s52
    s_mov_b32 s58, s32
    s_mov_b32 s18, 0x200000
    s_mov_b32 s19, 0x20000
    s_mov_b32 s22, 0x200000
    s_mov_b32 s23, 0x20000
    s_waitcnt lgkmcnt(0)

    s_add_u32 s16, s6, s29
    s_addc_u32 s17, s7, 0

    s_add_u32 s20, s8, s29
    s_addc_u32 s21, s9, 0

    s_lshl_b32 s30, s25, 10
    s_add_u32 s38, s14, s30
    s_addc_u32 s39, s15, 0

    s_mov_b32 s31, 0
    s_add_u32 s33, s31, 0
    s_mov_b32 m0, s33
    s_add_u32 s35, s56, 0
    buffer_load_dwordx4 v1, s[16:19], s35 offen offset:0 nt lds
    s_add_u32 s35, s56, 3072
    buffer_load_dwordx4 v2, s[16:19], s35 offen offset:1024 nt lds
    s_add_u32 s35, s56, 6144
    buffer_load_dwordx4 v1, s[16:19], s35 offen offset:2048 nt lds
    s_add_u32 s35, s56, 9216
    buffer_load_dwordx4 v2, s[16:19], s35 offen offset:3072 nt lds
    s_add_u32 s33, s31, 4096
    s_mov_b32 m0, s33
    s_add_u32 s35, s56, 16384
    buffer_load_dwordx4 v1, s[16:19], s35 offen offset:0 nt lds
    s_add_u32 s35, s56, 19456
    buffer_load_dwordx4 v2, s[16:19], s35 offen offset:1024 nt lds
    s_add_u32 s35, s56, 22528
    buffer_load_dwordx4 v1, s[16:19], s35 offen offset:2048 nt lds
    s_add_u32 s35, s56, 25600
    buffer_load_dwordx4 v2, s[16:19], s35 offen offset:3072 nt lds
    s_mov_b32 s31, 0
    s_add_u32 s33, s31, 8192
    s_mov_b32 m0, s33
    s_add_u32 s35, s56, 0
    buffer_load_dwordx4 v1, s[20:23], s35 offen offset:0 nt lds
    s_add_u32 s35, s56, 3072
    buffer_load_dwordx4 v2, s[20:23], s35 offen offset:1024 nt lds
    s_add_u32 s35, s56, 6144
    buffer_load_dwordx4 v1, s[20:23], s35 offen offset:2048 nt lds
    s_add_u32 s35, s56, 9216
    buffer_load_dwordx4 v2, s[20:23], s35 offen offset:3072 nt lds
    s_add_u32 s33, s31, 12288
    s_mov_b32 m0, s33
    s_add_u32 s35, s56, 16384
    buffer_load_dwordx4 v1, s[20:23], s35 offen offset:0 nt lds
    s_add_u32 s35, s56, 19456
    buffer_load_dwordx4 v2, s[20:23], s35 offen offset:1024 nt lds
    s_add_u32 s35, s56, 22528
    buffer_load_dwordx4 v1, s[20:23], s35 offen offset:2048 nt lds
    s_add_u32 s35, s56, 25600
    buffer_load_dwordx4 v2, s[20:23], s35 offen offset:3072 nt lds
    s_mov_b32 s31, 16384
    s_add_u32 s33, s31, 0
    s_mov_b32 m0, s33
    s_add_u32 s35, s57, 0
    buffer_load_dwordx4 v1, s[16:19], s35 offen offset:0 nt lds
    s_add_u32 s35, s57, 3072
    buffer_load_dwordx4 v2, s[16:19], s35 offen offset:1024 nt lds
    s_add_u32 s35, s57, 6144
    buffer_load_dwordx4 v1, s[16:19], s35 offen offset:2048 nt lds
    s_add_u32 s35, s57, 9216
    buffer_load_dwordx4 v2, s[16:19], s35 offen offset:3072 nt lds
    s_add_u32 s33, s31, 4096
    s_mov_b32 m0, s33
    s_add_u32 s35, s57, 16384
    buffer_load_dwordx4 v1, s[16:19], s35 offen offset:0 nt lds
    s_add_u32 s35, s57, 19456
    buffer_load_dwordx4 v2, s[16:19], s35 offen offset:1024 nt lds
    s_add_u32 s35, s57, 22528
    buffer_load_dwordx4 v1, s[16:19], s35 offen offset:2048 nt lds
    s_add_u32 s35, s57, 25600
    buffer_load_dwordx4 v2, s[16:19], s35 offen offset:3072 nt lds
    s_mov_b32 s31, 16384
    s_add_u32 s33, s31, 8192
    s_mov_b32 m0, s33
    s_add_u32 s35, s57, 0
    s_waitcnt vmcnt(23)
    buffer_load_dwordx4 v1, s[20:23], s35 offen offset:0 nt lds
    s_add_u32 s35, s57, 3072
    s_waitcnt vmcnt(23)
    buffer_load_dwordx4 v2, s[20:23], s35 offen offset:1024 nt lds
    s_add_u32 s35, s57, 6144
    s_waitcnt vmcnt(23)
    buffer_load_dwordx4 v1, s[20:23], s35 offen offset:2048 nt lds
    s_add_u32 s35, s57, 9216
    s_waitcnt vmcnt(23)
    buffer_load_dwordx4 v2, s[20:23], s35 offen offset:3072 nt lds
    s_add_u32 s33, s31, 12288
    s_mov_b32 m0, s33
    s_add_u32 s35, s57, 16384
    s_waitcnt vmcnt(23)
    buffer_load_dwordx4 v1, s[20:23], s35 offen offset:0 nt lds
    s_add_u32 s35, s57, 19456
    s_waitcnt vmcnt(23)
    buffer_load_dwordx4 v2, s[20:23], s35 offen offset:1024 nt lds
    s_add_u32 s35, s57, 22528
    s_waitcnt vmcnt(23)
    buffer_load_dwordx4 v1, s[20:23], s35 offen offset:2048 nt lds
    s_add_u32 s35, s57, 25600
    s_waitcnt vmcnt(23)
    buffer_load_dwordx4 v2, s[20:23], s35 offen offset:3072 nt lds
    s_mov_b32 s31, 32768
    s_add_u32 s33, s31, 0
    s_mov_b32 m0, s33
    s_add_u32 s35, s58, 0
    s_waitcnt vmcnt(23)
    buffer_load_dwordx4 v1, s[16:19], s35 offen offset:0 nt lds
    s_add_u32 s35, s58, 3072
    s_waitcnt vmcnt(23)
    buffer_load_dwordx4 v2, s[16:19], s35 offen offset:1024 nt lds
    s_add_u32 s35, s58, 6144
    s_waitcnt vmcnt(23)
    buffer_load_dwordx4 v1, s[16:19], s35 offen offset:2048 nt lds
    s_add_u32 s35, s58, 9216
    s_waitcnt vmcnt(23)
    buffer_load_dwordx4 v2, s[16:19], s35 offen offset:3072 nt lds
    s_add_u32 s33, s31, 4096
    s_mov_b32 m0, s33
    s_add_u32 s35, s58, 16384
    s_waitcnt vmcnt(23)
    buffer_load_dwordx4 v1, s[16:19], s35 offen offset:0 nt lds
    s_add_u32 s35, s58, 19456
    s_waitcnt vmcnt(23)
    buffer_load_dwordx4 v2, s[16:19], s35 offen offset:1024 nt lds
    s_add_u32 s35, s58, 22528
    s_waitcnt vmcnt(23)
    buffer_load_dwordx4 v1, s[16:19], s35 offen offset:2048 nt lds
    s_add_u32 s35, s58, 25600
    s_waitcnt vmcnt(23)
    buffer_load_dwordx4 v2, s[16:19], s35 offen offset:3072 nt lds
    s_mov_b32 s34, s58
    s_mov_b32 s54, 32768
    s_mov_b32 s31, 49152

    s_mov_b32 s36, 0
L_lloop:
    s_waitcnt lgkmcnt(0)
    s_barrier
    s_cmp_lt_u32 s36, 54
    s_cbranch_scc1 L_noclaim4
    s_and_b32 s48, s36, 3
    s_lshl_b64 exec, 1, s48
    global_atomic_add v20, v23, v24, s[38:39] sc0
    s_mov_b64 exec, -1

L_noclaim4:
    s_add_u32 s33, s54, 8192
    s_mov_b32 m0, s33
    s_add_u32 s35, s34, 0
    s_waitcnt vmcnt(23)
    buffer_load_dwordx4 v1, s[20:23], s35 offen offset:0 nt lds
    s_add_u32 s35, s34, 3072
    s_waitcnt vmcnt(23)
    buffer_load_dwordx4 v2, s[20:23], s35 offen offset:1024 nt lds
    s_add_u32 s35, s34, 6144
    s_waitcnt vmcnt(23)
    buffer_load_dwordx4 v1, s[20:23], s35 offen offset:2048 nt lds
    s_add_u32 s35, s34, 9216
    s_waitcnt vmcnt(23)
    buffer_load_dwordx4 v2, s[20:23], s35 offen offset:3072 nt lds
    s_add_u32 s33, s54, 12288
    s_mov_b32 m0, s33
    s_add_u32 s35, s34, 16384
    s_waitcnt vmcnt(23)
    buffer_load_dwordx4 v1, s[20:23], s35 offen offset:0 nt lds
    s_add_u32 s35, s34, 19456
    s_waitcnt vmcnt(23)
    buffer_load_dwordx4 v2, s[20:23], s35 offen offset:1024 nt lds
    s_add_u32 s35, s34, 22528
    s_waitcnt vmcnt(23)
    buffer_load_dwordx4 v1, s[20:23], s35 offen offset:2048 nt lds
    s_add_u32 s35, s34, 25600
    s_waitcnt vmcnt(23)
    buffer_load_dwordx4 v2, s[20:23], s35 offen offset:3072 nt lds
    s_add_u32 s47, s36, 3
    s_mov_b32 s32, s47
    s_add_u32 s32, s46, s32
    s_cmp_lt_u32 s47, 58
    s_cbranch_scc1 L_static

    s_and_b32 s48, s47, 3
    v_readlane_b32 s32, v20, s48
    s_nop 3
    s_add_u32 s32, s32, 232

    s_cmp_lt_u32 s32, 256
    s_cbranch_scc0 L_lendgame

L_static:
    s_bfe_u32 s52, s32, 0x20000
    s_lshl_b32 s52, s52, 10
    s_bfe_u32 s53, s32, 0x60002
    s_lshl_b32 s53, s53, 15
    s_add_u32 s52, s52, s53
    s_mov_b32 s32, s52
    s_add_u32 s33, s31, 0
    s_mov_b32 m0, s33
    s_add_u32 s35, s32, 0
    s_waitcnt vmcnt(23)
    buffer_load_dwordx4 v1, s[16:19], s35 offen offset:0 nt lds
    s_add_u32 s35, s32, 3072
    s_waitcnt vmcnt(23)
    buffer_load_dwordx4 v2, s[16:19], s35 offen offset:1024 nt lds
    s_add_u32 s35, s32, 6144
    s_waitcnt vmcnt(23)
    buffer_load_dwordx4 v1, s[16:19], s35 offen offset:2048 nt lds
    s_add_u32 s35, s32, 9216
    s_waitcnt vmcnt(23)
    buffer_load_dwordx4 v2, s[16:19], s35 offen offset:3072 nt lds
    s_add_u32 s33, s31, 4096
    s_mov_b32 m0, s33
    s_add_u32 s35, s32, 16384
    s_waitcnt vmcnt(23)
    buffer_load_dwordx4 v1, s[16:19], s35 offen offset:0 nt lds
    s_add_u32 s35, s32, 19456
    s_waitcnt vmcnt(23)
    buffer_load_dwordx4 v2, s[16:19], s35 offen offset:1024 nt lds
    s_add_u32 s35, s32, 22528
    s_waitcnt vmcnt(23)
    buffer_load_dwordx4 v1, s[16:19], s35 offen offset:2048 nt lds
    s_add_u32 s35, s32, 25600
    s_waitcnt vmcnt(23)
    buffer_load_dwordx4 v2, s[16:19], s35 offen offset:3072 nt lds
    s_mov_b32 s34, s32
    s_mov_b32 s54, s31
    s_add_u32 s31, s31, 16384
    s_and_b32 s31, s31, 65535

    s_cmp_eq_u32 s36, 46
    s_cbranch_scc0 L_nohs1
    global_load_dwordx2 v[26:27], v23, s[12:13] sc1

L_nohs1:
    s_cmp_eq_u32 s36, 49
    s_cbranch_scc0 L_nohs2
    s_mov_b32 s50, 65536

L_lhs:
    v_readfirstlane_b32 s48, v26
    s_sub_u32 s50, s50, 1
    s_cmp_eq_u32 s50, 0
    s_cbranch_scc1 L_hsok
    s_cmp_lg_u32 s48, 0
    s_cbranch_scc1 L_hsok
    global_load_dwordx2 v[26:27], v23, s[12:13] sc1
    s_waitcnt vmcnt(0)
    s_branch L_lhs

L_hsok:
    ds_write_b64 v22, v[26:27] offset:8
L_nohs2:
    s_add_u32 s36, s36, 1
    s_branch L_lloop

L_lendgame:
    v_mov_b32 v21, s47
    ds_write_b32 v22, v21
    s_waitcnt vmcnt(17) lgkmcnt(0)
    s_barrier
    s_waitcnt vmcnt(9)
    s_barrier
    s_waitcnt vmcnt(0)
    s_barrier

L_lend:
    s_waitcnt vmcnt(0)
    s_endpgm
L_comp:
    v_and_b32 v4, 15, v3
    v_lshrrev_b32 v5, 4, v3
    s_lshl_b32 s27, s25, 2
    s_add_u32 s27, s27, s24
    s_lshl_b32 s28, s27, 12
    v_lshlrev_b32 v6, 8, v4
    v_lshl_add_u32 v7, v5, 4, v6
    s_waitcnt lgkmcnt(0)
    s_add_u32 s4, s4, s28
    s_addc_u32 s5, s5, 0

    global_load_dwordx4 v[16:19], v7, s[4:5] offset:0
    global_load_dwordx4 v[20:23], v7, s[4:5] offset:64
    global_load_dwordx4 v[24:27], v7, s[4:5] offset:128
    global_load_dwordx4 v[28:31], v7, s[4:5] offset:192
    s_or_b32 s30, s2, s24
    s_cmp_lg_u32 s30, 0
    s_cbranch_scc1 L_noclear
    s_memrealtime s[50:51]
    v_mov_b32 v8, 0
    v_mov_b32 v9, 0
    v_mov_b32 v10, 0
    v_mov_b32 v11, 0
    v_lshlrev_b32 v12, 10, v3
    global_store_dwordx4 v12, v[8:11], s[14:15] sc1
    s_waitcnt vmcnt(0) lgkmcnt(0)
    s_or_b32 s50, s50, 1
    v_mov_b32 v14, s50
    v_mov_b32 v15, s51
    s_mov_b64 exec, 1
    global_store_dwordx2 v8, v[14:15], s[12:13] sc1
    s_mov_b64 exec, -1

L_noclear:
    s_lshl_b32 s28, s27, 15
    s_add_u32 s40, s14, s28
    s_addc_u32 s41, s15, 0
    s_add_u32 s40, s40, 1048576
    s_addc_u32 s41, s41, 0
    s_lshl_b32 s28, s27, 12
    s_add_u32 s10, s10, s28
    s_addc_u32 s11, s11, 0
    v_lshlrev_b32 v7, 4, v3
    v_lshlrev_b32 v6, 8, v4
    v_lshl_add_u32 v6, v5, 3, v6
    s_lshl_b32 s28, s26, 6
    v_add_u32 v216, s28, v6
    s_lshl_b32 s28, s26, 8
    s_add_u32 s28, s28, 16384
    v_lshl_add_u32 v217, v4, 4, s28
    s_lshl_b32 s28, s26, 7
    s_add_u32 s28, s28, 17408
    v_mov_b32 v221, s28
    v_and_b32 v8, 3, v3
    v_lshlrev_b32 v8, 7, v8
    v_add_u32 v222, 17408, v8

    v_and_b32 v8, 3, v3
    s_add_u32 s28, s26, 1
    v_add_u32 v8, s28, v8
    v_and_b32 v8, 3, v8
    v_lshrrev_b32 v9, 2, v3
    v_lshlrev_b32 v9, 3, v9
    s_lshl_b32 s28, s26, 7
    s_add_u32 s28, s28, 18432
    v_lshl_add_u32 v10, v8, 9, v9
    v_add_u32 v221, s28, v10
    s_lshl_b32 s28, s26, 9
    s_add_u32 s28, s28, 18432
    v_lshl_add_u32 v10, v8, 7, v9
    v_add_u32 v222, s28, v10
    s_mov_b32 s84, 0x11111111
    s_mov_b32 s85, 0x11111111
    s_mov_b32 s86, 0x22222222
    s_mov_b32 s87, 0x22222222
    s_mov_b32 s88, 0x77777777
    s_mov_b32 s89, 0x77777777

    s_mov_b32 s76, 0x9e3579b1
    s_mov_b32 s77, 0x85eb4a6b
    s_mov_b32 s78, 0xc2b3ae35
    s_mov_b32 s79, 0x27d52f2f
    s_mov_b32 s80, 0x165767b1
    s_mov_b32 s81, 0xd3a3646d
    s_mov_b32 s82, 0xfd71c5a7
    s_mov_b32 s90, 4096
    s_add_u32 s28, s26, 1
    s_and_b32 s28, s28, 3
    s_lshl_b32 s29, s28, 2
    s_add_u32 s29, s29, s26
    s_lshl_b32 s29, s29, 10
    v_add_u32 v210, s29, v7
    s_lshl_b32 s29, s26, 2
    s_add_u32 s29, s29, s28
    s_lshl_b32 s29, s29, 10
    v_add_u32 v213, s29, v7
    s_lshl_b32 s29, s28, 8
    s_add_u32 s29, s29, 16384
    v_lshl_add_u32 v218, v4, 4, s29

    s_add_u32 s28, s26, 2
    s_and_b32 s28, s28, 3
    s_lshl_b32 s29, s28, 2
    s_add_u32 s29, s29, s26
    s_lshl_b32 s29, s29, 10
    v_add_u32 v211, s29, v7
    s_lshl_b32 s29, s26, 2
    s_add_u32 s29, s29, s28
    s_lshl_b32 s29, s29, 10
    v_add_u32 v214, s29, v7
    s_lshl_b32 s29, s28, 8
    s_add_u32 s29, s29, 16384
    v_lshl_add_u32 v219, v4, 4, s29

    s_add_u32 s28, s26, 3
    s_and_b32 s28, s28, 3
    s_lshl_b32 s29, s28, 2
    s_add_u32 s29, s29, s26
    s_lshl_b32 s29, s29, 10
    v_add_u32 v212, s29, v7
    s_lshl_b32 s29, s26, 2
    s_add_u32 s29, s29, s28
    s_lshl_b32 s29, s29, 10
    v_add_u32 v215, s29, v7
    s_lshl_b32 s29, s28, 8
    s_add_u32 s29, s29, 16384
    v_lshl_add_u32 v220, v4, 4, s29

    v_and_b32 v7, 7, v4
    v_lshlrev_b32 v7, 1, v7
    v_xor_b32 v7, v7, v5
    v_lshlrev_b32 v7, 4, v7
    v_lshl_add_u32 v188, v4, 8, v7

    v_xor_b32 v189, 64, v188
    v_xor_b32 v190, 128, v188
    v_xor_b32 v191, 192, v188
    v_lshrrev_b32 v7, 2, v4
    v_lshl_add_u32 v7, v5, 2, v7
    v_and_b32 v14, 7, v7
    v_and_b32 v15, 3, v3
    v_lshlrev_b32 v15, 3, v15
    v_lshl_add_u32 v15, v7, 8, v15
    v_lshl_add_u32 v15, v14, 5, v15
    s_lshl_b32 s30, s26, 1

    s_add_u32 s34, s30, 0
    s_and_b32 s34, s34, 7
    s_lshl_b32 s34, s34, 5
    v_xor_b32 v192, s34, v15
    s_add_u32 s34, s30, 1
    s_and_b32 s34, s34, 7
    s_lshl_b32 s34, s34, 5
    v_xor_b32 v193, s34, v15
    s_add_u32 s34, s30, 2
    s_and_b32 s34, s34, 7
    s_lshl_b32 s34, s34, 5
    v_xor_b32 v194, s34, v15
    s_add_u32 s34, s30, 3
    s_and_b32 s34, s34, 7
    s_lshl_b32 s34, s34, 5
    v_xor_b32 v195, s34, v15
    s_add_u32 s34, s30, 4
    s_and_b32 s34, s34, 7
    s_lshl_b32 s34, s34, 5
    v_xor_b32 v196, s34, v15
    s_add_u32 s34, s30, 5
    s_and_b32 s34, s34, 7
    s_lshl_b32 s34, s34, 5
    v_xor_b32 v197, s34, v15
    s_add_u32 s34, s30, 6
    s_and_b32 s34, s34, 7
    s_lshl_b32 s34, s34, 5
    v_xor_b32 v198, s34, v15
    s_add_u32 s34, s30, 7
    s_and_b32 s34, s34, 7
    s_lshl_b32 s34, s34, 5
    v_xor_b32 v199, s34, v15
    v_mov_b32 v148, 0
    v_mov_b32 v149, 0
    v_mov_b32 v150, 0
    v_mov_b32 v151, 0
    v_mov_b32 v152, 0
    v_mov_b32 v153, 0
    v_mov_b32 v154, 0
    v_mov_b32 v155, 0
    v_mov_b32 v156, 0
    v_mov_b32 v157, 0
    v_mov_b32 v158, 0
    v_mov_b32 v159, 0
    v_mov_b32 v160, 0
    v_mov_b32 v161, 0
    v_mov_b32 v162, 0
    v_mov_b32 v163, 0
    v_mov_b32 v164, 0
    v_mov_b32 v165, 0
    v_mov_b32 v166, 0
    v_mov_b32 v167, 0
    v_mov_b32 v168, 0
    v_mov_b32 v169, 0
    v_mov_b32 v170, 0
    v_mov_b32 v171, 0
    v_mov_b32 v172, 0
    v_mov_b32 v173, 0
    v_mov_b32 v174, 0
    v_mov_b32 v175, 0
    v_mov_b32 v176, 0
    v_mov_b32 v177, 0
    v_mov_b32 v178, 0
    v_mov_b32 v179, 0
    v_mov_b32 v180, 0
    v_mov_b32 v181, 0
    v_mov_b32 v182, 0
    v_mov_b32 v183, 0
    v_mov_b32 v184, 0x3f803f80
    v_mov_b32 v185, 0x3f803f80
    v_mov_b32 v186, 0x3f803f80
    v_mov_b32 v187, 0x3f803f80
    v_mov_b32 v96, 0
    v_mov_b32 v97, 0
    v_mov_b32 v98, 0
    v_mov_b32 v99, 0
    v_mov_b32 v100, 0
    v_mov_b32 v101, 0
    v_mov_b32 v102, 0
    v_mov_b32 v103, 0
    v_mov_b32 v104, 0
    v_mov_b32 v105, 0
    v_mov_b32 v106, 0
    v_mov_b32 v107, 0
    v_mov_b32 v108, 0
    v_mov_b32 v109, 0
    v_mov_b32 v110, 0
    v_mov_b32 v111, 0
    v_mov_b32 v112, 0
    v_mov_b32 v113, 0
    v_mov_b32 v114, 0
    v_mov_b32 v115, 0
    v_mov_b32 v116, 0
    v_mov_b32 v117, 0
    v_mov_b32 v118, 0
    v_mov_b32 v119, 0
    v_mov_b32 v120, 0
    v_mov_b32 v121, 0
    v_mov_b32 v122, 0
    v_mov_b32 v123, 0
    v_mov_b32 v124, 0
    v_mov_b32 v125, 0
    v_mov_b32 v126, 0
    v_mov_b32 v127, 0
    v_mov_b32 v136, 0xff800000
    v_mov_b32 v137, 0xff800000
    v_mov_b32 v138, 0xff800000
    v_mov_b32 v139, 0xff800000
    v_mov_b32 v140, 0xff800000
    v_mov_b32 v141, 0xff800000
    v_mov_b32 v142, 0xff800000
    v_mov_b32 v143, 0xff800000
    v_mov_b32 v200, 0xff61b1e6
    v_mov_b32 v201, 0xff61b1e6
    v_mov_b32 v202, 0xff61b1e6
    v_mov_b32 v207, 65536
    s_mov_b32 s37, 0x3e0293ee
    s_mov_b32 s44, 0x427af233
    s_mov_b32 s36, 1
    s_lshl_b32 s45, 1, s26
    s_waitcnt vmcnt(0)

L_cloop:
    v_max3_f32 v203, v136, v137, v138
    v_max3_f32 v204, v139, v140, v141
    v_max3_f32 v203, v203, v142, v143
    v_max_f32 v203, v203, v204
    v_cmp_gt_f32 vcc, v203, v202
    s_cbranch_vccnz L_rare0

L_ret0:
    v_fma_f32 v136, v136, s37, -v201
    v_fma_f32 v137, v137, s37, -v201
    v_fma_f32 v138, v138, s37, -v201
    v_fma_f32 v139, v139, s37, -v201
    v_fma_f32 v140, v140, s37, -v201
    v_fma_f32 v141, v141, s37, -v201
    v_fma_f32 v142, v142, s37, -v201
    v_fma_f32 v143, v143, s37, -v201
    v_exp_f32 v136, v136
    v_exp_f32 v137, v137
    v_exp_f32 v138, v138
    v_exp_f32 v139, v139
    v_exp_f32 v140, v140
    v_exp_f32 v141, v141
    v_exp_f32 v142, v142
    v_exp_f32 v143, v143
    v_cvt_pk_bf16_f32 v144, v136, v137
    v_cvt_pk_bf16_f32 v145, v138, v139
    v_cvt_pk_bf16_f32 v146, v140, v141
    v_cvt_pk_bf16_f32 v147, v142, v143
    s_nop 1
    v_mfma_f32_16x16x32_bf16 v[180:183], v[184:187], v[144:147], v[180:183]
    v_mfma_f32_16x16x32_bf16 v[148:151], v[96:99], v[144:147], v[148:151]
    v_mfma_f32_16x16x32_bf16 v[152:155], v[100:103], v[144:147], v[152:155]
    v_mfma_f32_16x16x32_bf16 v[156:159], v[104:107], v[144:147], v[156:159]
    v_mfma_f32_16x16x32_bf16 v[160:163], v[108:111], v[144:147], v[160:163]
    v_mfma_f32_16x16x32_bf16 v[164:167], v[112:115], v[144:147], v[164:167]
    v_mfma_f32_16x16x32_bf16 v[168:171], v[116:119], v[144:147], v[168:171]
    v_mfma_f32_16x16x32_bf16 v[172:175], v[120:123], v[144:147], v[172:175]
    v_mfma_f32_16x16x32_bf16 v[176:179], v[124:127], v[144:147], v[176:179]
    s_barrier
    ds_read_b32 v208, v207
    ds_read_b128 v[32:35], v188 offset:0
    ds_read_b128 v[36:39], v189 offset:0
    ds_read_b128 v[40:43], v190 offset:0
    ds_read_b128 v[44:47], v191 offset:0
    ds_read_b128 v[48:51], v188 offset:4096
    ds_read_b128 v[52:55], v189 offset:4096
    ds_read_b128 v[56:59], v190 offset:4096
    ds_read_b128 v[60:63], v191 offset:4096
    ds_read_b64_tr_b16 v[64:65], v192 offset:8192
    ds_read_b64_tr_b16 v[66:67], v192 offset:12288
    ds_read_b64_tr_b16 v[68:69], v193 offset:8192
    ds_read_b64_tr_b16 v[70:71], v193 offset:12288
    ds_read_b64_tr_b16 v[72:73], v194 offset:8192
    ds_read_b64_tr_b16 v[74:75], v194 offset:12288
    s_waitcnt lgkmcnt(6)
    v_mfma_f32_16x16x32_bf16 v[128:131], v[32:35], v[16:19], 0
    v_mfma_f32_16x16x32_bf16 v[132:135], v[48:51], v[16:19], 0
    ds_read_b64_tr_b16 v[76:77], v195 offset:8192
    ds_read_b64_tr_b16 v[78:79], v195 offset:12288
    v_mfma_f32_16x16x32_bf16 v[128:131], v[36:39], v[20:23], v[128:131]
    v_mfma_f32_16x16x32_bf16 v[132:135], v[52:55], v[20:23], v[132:135]
    ds_read_b64_tr_b16 v[80:81], v196 offset:8192
    ds_read_b64_tr_b16 v[82:83], v196 offset:12288
    v_mfma_f32_16x16x32_bf16 v[128:131], v[40:43], v[24:27], v[128:131]
    v_mfma_f32_16x16x32_bf16 v[132:135], v[56:59], v[24:27], v[132:135]
    ds_read_b64_tr_b16 v[84:85], v197 offset:8192
    ds_read_b64_tr_b16 v[86:87], v197 offset:12288
    v_mfma_f32_16x16x32_bf16 v[128:131], v[44:47], v[28:31], v[128:131]
    v_mfma_f32_16x16x32_bf16 v[132:135], v[60:63], v[28:31], v[132:135]
    s_waitcnt lgkmcnt(11)
    ds_read_b64_tr_b16 v[88:89], v198 offset:8192
    ds_read_b64_tr_b16 v[90:91], v198 offset:12288
    ds_read_b64_tr_b16 v[92:93], v199 offset:8192
    ds_read_b64_tr_b16 v[94:95], v199 offset:12288
    s_add_u32 s36, s36, 1
    s_waitcnt lgkmcnt(0)
    v_cmp_eq_u32 vcc, s36, v208
    s_cbranch_vccnz L_last1
    v_max3_f32 v203, v128, v129, v130
    v_max3_f32 v204, v131, v132, v133
    v_max3_f32 v203, v203, v134, v135
    v_max_f32 v203, v203, v204
    v_cmp_gt_f32 vcc, v203, v202
    s_cbranch_vccnz L_rare1

L_ret1:
    v_fma_f32 v128, v128, s37, -v201
    v_fma_f32 v129, v129, s37, -v201
    v_fma_f32 v130, v130, s37, -v201
    v_fma_f32 v131, v131, s37, -v201
    v_fma_f32 v132, v132, s37, -v201
    v_fma_f32 v133, v133, s37, -v201
    v_fma_f32 v134, v134, s37, -v201
    v_fma_f32 v135, v135, s37, -v201
    v_exp_f32 v128, v128
    v_exp_f32 v129, v129
    v_exp_f32 v130, v130
    v_exp_f32 v131, v131
    v_exp_f32 v132, v132
    v_exp_f32 v133, v133
    v_exp_f32 v134, v134
    v_exp_f32 v135, v135
    v_cvt_pk_bf16_f32 v144, v128, v129
    v_cvt_pk_bf16_f32 v145, v130, v131
    v_cvt_pk_bf16_f32 v146, v132, v133
    v_cvt_pk_bf16_f32 v147, v134, v135
    s_nop 1
    v_mfma_f32_16x16x32_bf16 v[180:183], v[184:187], v[144:147], v[180:183]
    v_mfma_f32_16x16x32_bf16 v[148:151], v[64:67], v[144:147], v[148:151]
    v_mfma_f32_16x16x32_bf16 v[152:155], v[68:71], v[144:147], v[152:155]
    v_mfma_f32_16x16x32_bf16 v[156:159], v[72:75], v[144:147], v[156:159]
    v_mfma_f32_16x16x32_bf16 v[160:163], v[76:79], v[144:147], v[160:163]
    v_mfma_f32_16x16x32_bf16 v[164:167], v[80:83], v[144:147], v[164:167]
    v_mfma_f32_16x16x32_bf16 v[168:171], v[84:87], v[144:147], v[168:171]
    v_mfma_f32_16x16x32_bf16 v[172:175], v[88:91], v[144:147], v[172:175]
    v_mfma_f32_16x16x32_bf16 v[176:179], v[92:95], v[144:147], v[176:179]
    s_barrier
    ds_read_b32 v208, v207
    ds_read_b128 v[32:35], v188 offset:16384
    ds_read_b128 v[36:39], v189 offset:16384
    ds_read_b128 v[40:43], v190 offset:16384
    ds_read_b128 v[44:47], v191 offset:16384
    ds_read_b128 v[48:51], v188 offset:20480
    ds_read_b128 v[52:55], v189 offset:20480
    ds_read_b128 v[56:59], v190 offset:20480
    ds_read_b128 v[60:63], v191 offset:20480
    ds_read_b64_tr_b16 v[96:97], v192 offset:24576
    ds_read_b64_tr_b16 v[98:99], v192 offset:28672
    ds_read_b64_tr_b16 v[100:101], v193 offset:24576
    ds_read_b64_tr_b16 v[102:103], v193 offset:28672
    ds_read_b64_tr_b16 v[104:105], v194 offset:24576
    ds_read_b64_tr_b16 v[106:107], v194 offset:28672
    s_waitcnt lgkmcnt(6)
    v_mfma_f32_16x16x32_bf16 v[136:139], v[32:35], v[16:19], 0
    v_mfma_f32_16x16x32_bf16 v[140:143], v[48:51], v[16:19], 0
    ds_read_b64_tr_b16 v[108:109], v195 offset:24576
    ds_read_b64_tr_b16 v[110:111], v195 offset:28672
    v_mfma_f32_16x16x32_bf16 v[136:139], v[36:39], v[20:23], v[136:139]
    v_mfma_f32_16x16x32_bf16 v[140:143], v[52:55], v[20:23], v[140:143]
    ds_read_b64_tr_b16 v[112:113], v196 offset:24576
    ds_read_b64_tr_b16 v[114:115], v196 offset:28672
    v_mfma_f32_16x16x32_bf16 v[136:139], v[40:43], v[24:27], v[136:139]
    v_mfma_f32_16x16x32_bf16 v[140:143], v[56:59], v[24:27], v[140:143]
    ds_read_b64_tr_b16 v[116:117], v197 offset:24576
    ds_read_b64_tr_b16 v[118:119], v197 offset:28672
    v_mfma_f32_16x16x32_bf16 v[136:139], v[44:47], v[28:31], v[136:139]
    v_mfma_f32_16x16x32_bf16 v[140:143], v[60:63], v[28:31], v[140:143]
    s_waitcnt lgkmcnt(11)
    ds_read_b64_tr_b16 v[120:121], v198 offset:24576
    ds_read_b64_tr_b16 v[122:123], v198 offset:28672
    ds_read_b64_tr_b16 v[124:125], v199 offset:24576
    ds_read_b64_tr_b16 v[126:127], v199 offset:28672
    s_add_u32 s36, s36, 1
    s_waitcnt lgkmcnt(0)
    v_cmp_eq_u32 vcc, s36, v208
    s_cbranch_vccnz L_last2
    v_max3_f32 v203, v136, v137, v138
    v_max3_f32 v204, v139, v140, v141
    v_max3_f32 v203, v203, v142, v143
    v_max_f32 v203, v203, v204
    v_cmp_gt_f32 vcc, v203, v202
    s_cbranch_vccnz L_rare2

L_ret2:
    v_fma_f32 v136, v136, s37, -v201
    v_fma_f32 v137, v137, s37, -v201
    v_fma_f32 v138, v138, s37, -v201
    v_fma_f32 v139, v139, s37, -v201
    v_fma_f32 v140, v140, s37, -v201
    v_fma_f32 v141, v141, s37, -v201
    v_fma_f32 v142, v142, s37, -v201
    v_fma_f32 v143, v143, s37, -v201
    v_exp_f32 v136, v136
    v_exp_f32 v137, v137
    v_exp_f32 v138, v138
    v_exp_f32 v139, v139
    v_exp_f32 v140, v140
    v_exp_f32 v141, v141
    v_exp_f32 v142, v142
    v_exp_f32 v143, v143
    v_cvt_pk_bf16_f32 v144, v136, v137
    v_cvt_pk_bf16_f32 v145, v138, v139
    v_cvt_pk_bf16_f32 v146, v140, v141
    v_cvt_pk_bf16_f32 v147, v142, v143
    s_nop 1
    v_mfma_f32_16x16x32_bf16 v[180:183], v[184:187], v[144:147], v[180:183]
    v_mfma_f32_16x16x32_bf16 v[148:151], v[96:99], v[144:147], v[148:151]
    v_mfma_f32_16x16x32_bf16 v[152:155], v[100:103], v[144:147], v[152:155]
    v_mfma_f32_16x16x32_bf16 v[156:159], v[104:107], v[144:147], v[156:159]
    v_mfma_f32_16x16x32_bf16 v[160:163], v[108:111], v[144:147], v[160:163]
    v_mfma_f32_16x16x32_bf16 v[164:167], v[112:115], v[144:147], v[164:167]
    v_mfma_f32_16x16x32_bf16 v[168:171], v[116:119], v[144:147], v[168:171]
    v_mfma_f32_16x16x32_bf16 v[172:175], v[120:123], v[144:147], v[172:175]
    v_mfma_f32_16x16x32_bf16 v[176:179], v[124:127], v[144:147], v[176:179]
    s_barrier
    ds_read_b32 v208, v207
    ds_read_b128 v[32:35], v188 offset:32768
    ds_read_b128 v[36:39], v189 offset:32768
    ds_read_b128 v[40:43], v190 offset:32768
    ds_read_b128 v[44:47], v191 offset:32768
    ds_read_b128 v[48:51], v188 offset:36864
    ds_read_b128 v[52:55], v189 offset:36864
    ds_read_b128 v[56:59], v190 offset:36864
    ds_read_b128 v[60:63], v191 offset:36864
    ds_read_b64_tr_b16 v[64:65], v192 offset:40960
    ds_read_b64_tr_b16 v[66:67], v192 offset:45056
    ds_read_b64_tr_b16 v[68:69], v193 offset:40960
    ds_read_b64_tr_b16 v[70:71], v193 offset:45056
    ds_read_b64_tr_b16 v[72:73], v194 offset:40960
    ds_read_b64_tr_b16 v[74:75], v194 offset:45056
    s_waitcnt lgkmcnt(6)
    v_mfma_f32_16x16x32_bf16 v[128:131], v[32:35], v[16:19], 0
    v_mfma_f32_16x16x32_bf16 v[132:135], v[48:51], v[16:19], 0
    ds_read_b64_tr_b16 v[76:77], v195 offset:40960
    ds_read_b64_tr_b16 v[78:79], v195 offset:45056
    v_mfma_f32_16x16x32_bf16 v[128:131], v[36:39], v[20:23], v[128:131]
    v_mfma_f32_16x16x32_bf16 v[132:135], v[52:55], v[20:23], v[132:135]
    ds_read_b64_tr_b16 v[80:81], v196 offset:40960
    ds_read_b64_tr_b16 v[82:83], v196 offset:45056
    v_mfma_f32_16x16x32_bf16 v[128:131], v[40:43], v[24:27], v[128:131]
    v_mfma_f32_16x16x32_bf16 v[132:135], v[56:59], v[24:27], v[132:135]
    ds_read_b64_tr_b16 v[84:85], v197 offset:40960
    ds_read_b64_tr_b16 v[86:87], v197 offset:45056
    v_mfma_f32_16x16x32_bf16 v[128:131], v[44:47], v[28:31], v[128:131]
    v_mfma_f32_16x16x32_bf16 v[132:135], v[60:63], v[28:31], v[132:135]
    s_waitcnt lgkmcnt(11)
    ds_read_b64_tr_b16 v[88:89], v198 offset:40960
    ds_read_b64_tr_b16 v[90:91], v198 offset:45056
    ds_read_b64_tr_b16 v[92:93], v199 offset:40960
    ds_read_b64_tr_b16 v[94:95], v199 offset:45056
    s_add_u32 s36, s36, 1
    s_waitcnt lgkmcnt(0)
    v_cmp_eq_u32 vcc, s36, v208
    s_cbranch_vccnz L_last3
    v_max3_f32 v203, v128, v129, v130
    v_max3_f32 v204, v131, v132, v133
    v_max3_f32 v203, v203, v134, v135
    v_max_f32 v203, v203, v204
    v_cmp_gt_f32 vcc, v203, v202
    s_cbranch_vccnz L_rare3

L_ret3:
    v_fma_f32 v128, v128, s37, -v201
    v_fma_f32 v129, v129, s37, -v201
    v_fma_f32 v130, v130, s37, -v201
    v_fma_f32 v131, v131, s37, -v201
    v_fma_f32 v132, v132, s37, -v201
    v_fma_f32 v133, v133, s37, -v201
    v_fma_f32 v134, v134, s37, -v201
    v_fma_f32 v135, v135, s37, -v201
    v_exp_f32 v128, v128
    v_exp_f32 v129, v129
    v_exp_f32 v130, v130
    v_exp_f32 v131, v131
    v_exp_f32 v132, v132
    v_exp_f32 v133, v133
    v_exp_f32 v134, v134
    v_exp_f32 v135, v135
    v_cvt_pk_bf16_f32 v144, v128, v129
    v_cvt_pk_bf16_f32 v145, v130, v131
    v_cvt_pk_bf16_f32 v146, v132, v133
    v_cvt_pk_bf16_f32 v147, v134, v135
    s_nop 1
    v_mfma_f32_16x16x32_bf16 v[180:183], v[184:187], v[144:147], v[180:183]
    v_mfma_f32_16x16x32_bf16 v[148:151], v[64:67], v[144:147], v[148:151]
    v_mfma_f32_16x16x32_bf16 v[152:155], v[68:71], v[144:147], v[152:155]
    v_mfma_f32_16x16x32_bf16 v[156:159], v[72:75], v[144:147], v[156:159]
    v_mfma_f32_16x16x32_bf16 v[160:163], v[76:79], v[144:147], v[160:163]
    v_mfma_f32_16x16x32_bf16 v[164:167], v[80:83], v[144:147], v[164:167]
    v_mfma_f32_16x16x32_bf16 v[168:171], v[84:87], v[144:147], v[168:171]
    v_mfma_f32_16x16x32_bf16 v[172:175], v[88:91], v[144:147], v[172:175]
    v_mfma_f32_16x16x32_bf16 v[176:179], v[92:95], v[144:147], v[176:179]
    s_barrier
    ds_read_b32 v208, v207
    ds_read_b128 v[32:35], v188 offset:49152
    ds_read_b128 v[36:39], v189 offset:49152
    ds_read_b128 v[40:43], v190 offset:49152
    ds_read_b128 v[44:47], v191 offset:49152
    ds_read_b128 v[48:51], v188 offset:53248
    ds_read_b128 v[52:55], v189 offset:53248
    ds_read_b128 v[56:59], v190 offset:53248
    ds_read_b128 v[60:63], v191 offset:53248
    ds_read_b64_tr_b16 v[96:97], v192 offset:57344
    ds_read_b64_tr_b16 v[98:99], v192 offset:61440
    ds_read_b64_tr_b16 v[100:101], v193 offset:57344
    ds_read_b64_tr_b16 v[102:103], v193 offset:61440
    ds_read_b64_tr_b16 v[104:105], v194 offset:57344
    ds_read_b64_tr_b16 v[106:107], v194 offset:61440
    s_waitcnt lgkmcnt(6)
    v_mfma_f32_16x16x32_bf16 v[136:139], v[32:35], v[16:19], 0
    v_mfma_f32_16x16x32_bf16 v[140:143], v[48:51], v[16:19], 0
    ds_read_b64_tr_b16 v[108:109], v195 offset:57344
    ds_read_b64_tr_b16 v[110:111], v195 offset:61440
    v_mfma_f32_16x16x32_bf16 v[136:139], v[36:39], v[20:23], v[136:139]
    v_mfma_f32_16x16x32_bf16 v[140:143], v[52:55], v[20:23], v[140:143]
    ds_read_b64_tr_b16 v[112:113], v196 offset:57344
    ds_read_b64_tr_b16 v[114:115], v196 offset:61440
    v_mfma_f32_16x16x32_bf16 v[136:139], v[40:43], v[24:27], v[136:139]
    v_mfma_f32_16x16x32_bf16 v[140:143], v[56:59], v[24:27], v[140:143]
    ds_read_b64_tr_b16 v[116:117], v197 offset:57344
    ds_read_b64_tr_b16 v[118:119], v197 offset:61440
    v_mfma_f32_16x16x32_bf16 v[136:139], v[44:47], v[28:31], v[136:139]
    v_mfma_f32_16x16x32_bf16 v[140:143], v[60:63], v[28:31], v[140:143]
    s_waitcnt lgkmcnt(11)
    ds_read_b64_tr_b16 v[120:121], v198 offset:57344
    ds_read_b64_tr_b16 v[122:123], v198 offset:61440
    ds_read_b64_tr_b16 v[124:125], v199 offset:57344
    ds_read_b64_tr_b16 v[126:127], v199 offset:61440
    s_add_u32 s36, s36, 1
    s_waitcnt lgkmcnt(0)
    v_cmp_eq_u32 vcc, s36, v208
    s_cbranch_vccnz L_last0
    s_branch L_cloop
L_last0:
    s_barrier
    ds_read_b128 v[32:35], v188 offset:0
    ds_read_b128 v[36:39], v189 offset:0
    ds_read_b128 v[40:43], v190 offset:0
    ds_read_b128 v[44:47], v191 offset:0
    ds_read_b128 v[48:51], v188 offset:4096
    ds_read_b128 v[52:55], v189 offset:4096
    ds_read_b128 v[56:59], v190 offset:4096
    ds_read_b128 v[60:63], v191 offset:4096
    ds_read_b64 v[208:209], v207 offset:8
    v_max3_f32 v203, v136, v137, v138
    v_max3_f32 v204, v139, v140, v141
    v_max3_f32 v203, v203, v142, v143
    v_max_f32 v203, v203, v204
    v_cmp_gt_f32 vcc, v203, v202
    s_cbranch_vccnz L_rarep0

L_retp0:
    v_fma_f32 v136, v136, s37, -v201
    v_fma_f32 v137, v137, s37, -v201
    v_fma_f32 v138, v138, s37, -v201
    v_fma_f32 v139, v139, s37, -v201
    v_fma_f32 v140, v140, s37, -v201
    v_fma_f32 v141, v141, s37, -v201
    v_fma_f32 v142, v142, s37, -v201
    v_fma_f32 v143, v143, s37, -v201
    v_exp_f32 v136, v136
    v_exp_f32 v137, v137
    v_exp_f32 v138, v138
    v_exp_f32 v139, v139
    v_exp_f32 v140, v140
    v_exp_f32 v141, v141
    v_exp_f32 v142, v142
    v_exp_f32 v143, v143
    v_cvt_pk_bf16_f32 v144, v136, v137
    v_cvt_pk_bf16_f32 v145, v138, v139
    v_cvt_pk_bf16_f32 v146, v140, v141
    v_cvt_pk_bf16_f32 v147, v142, v143
    s_nop 1
    v_mfma_f32_16x16x32_bf16 v[180:183], v[184:187], v[144:147], v[180:183]
    v_mfma_f32_16x16x32_bf16 v[148:151], v[96:99], v[144:147], v[148:151]
    v_mfma_f32_16x16x32_bf16 v[152:155], v[100:103], v[144:147], v[152:155]
    v_mfma_f32_16x16x32_bf16 v[156:159], v[104:107], v[144:147], v[156:159]
    v_mfma_f32_16x16x32_bf16 v[160:163], v[108:111], v[144:147], v[160:163]
    s_waitcnt lgkmcnt(0)
    v_mfma_f32_16x16x32_bf16 v[128:131], v[32:35], v[16:19], 0
    v_mfma_f32_16x16x32_bf16 v[132:135], v[48:51], v[16:19], 0
    v_mfma_f32_16x16x32_bf16 v[128:131], v[36:39], v[20:23], v[128:131]
    v_mfma_f32_16x16x32_bf16 v[132:135], v[52:55], v[20:23], v[132:135]
    v_mfma_f32_16x16x32_bf16 v[128:131], v[40:43], v[24:27], v[128:131]
    v_mfma_f32_16x16x32_bf16 v[132:135], v[56:59], v[24:27], v[132:135]
    v_mfma_f32_16x16x32_bf16 v[128:131], v[44:47], v[28:31], v[128:131]
    v_mfma_f32_16x16x32_bf16 v[132:135], v[60:63], v[28:31], v[132:135]
    v_mfma_f32_16x16x32_bf16 v[164:167], v[112:115], v[144:147], v[164:167]
    v_mfma_f32_16x16x32_bf16 v[168:171], v[116:119], v[144:147], v[168:171]
    v_mfma_f32_16x16x32_bf16 v[172:175], v[120:123], v[144:147], v[172:175]
    v_mfma_f32_16x16x32_bf16 v[176:179], v[124:127], v[144:147], v[176:179]
    s_nop 3
    v_max3_f32 v203, v128, v129, v130
    v_max3_f32 v204, v131, v132, v133
    v_max3_f32 v203, v203, v134, v135
    v_max_f32 v203, v203, v204
    v_cmp_gt_f32 vcc, v203, v202
    s_cbranch_vccnz L_rarec0

L_retc0:
    v_fma_f32 v128, v128, s37, -v201
    v_fma_f32 v129, v129, s37, -v201
    v_fma_f32 v130, v130, s37, -v201
    v_fma_f32 v131, v131, s37, -v201
    v_fma_f32 v132, v132, s37, -v201
    v_fma_f32 v133, v133, s37, -v201
    v_fma_f32 v134, v134, s37, -v201
    v_fma_f32 v135, v135, s37, -v201
    v_exp_f32 v128, v128
    v_exp_f32 v129, v129
    v_exp_f32 v130, v130
    v_exp_f32 v131, v131
    v_exp_f32 v132, v132
    v_exp_f32 v133, v133
    v_exp_f32 v134, v134
    v_exp_f32 v135, v135
    v_cvt_pk_bf16_f32 v144, v128, v129
    v_cvt_pk_bf16_f32 v145, v130, v131
    v_cvt_pk_bf16_f32 v146, v132, v133
    v_cvt_pk_bf16_f32 v147, v134, v135
    s_barrier
    ds_read_b64_tr_b16 v[72:73], v194 offset:8192
    ds_read_b64_tr_b16 v[74:75], v194 offset:12288
    ds_read_b64_tr_b16 v[76:77], v195 offset:8192
    ds_read_b64_tr_b16 v[78:79], v195 offset:12288
    ds_read_b64_tr_b16 v[80:81], v196 offset:8192
    ds_read_b64_tr_b16 v[82:83], v196 offset:12288
    ds_read_b64_tr_b16 v[84:85], v197 offset:8192
    ds_read_b64_tr_b16 v[86:87], v197 offset:12288
    ds_read_b64_tr_b16 v[88:89], v198 offset:8192
    ds_read_b64_tr_b16 v[90:91], v198 offset:12288
    ds_read_b64_tr_b16 v[92:93], v199 offset:8192
    ds_read_b64_tr_b16 v[94:95], v199 offset:12288
    v_mfma_f32_16x16x32_bf16 v[180:183], v[184:187], v[144:147], v[180:183]
    s_waitcnt lgkmcnt(10)
    v_mfma_f32_16x16x32_bf16 v[156:159], v[72:75], v[144:147], v[156:159]
    ds_read_b64_tr_b16 v[64:65], v192 offset:8192
    ds_read_b64_tr_b16 v[66:67], v192 offset:12288
    s_waitcnt lgkmcnt(10)
    v_mfma_f32_16x16x32_bf16 v[160:163], v[76:79], v[144:147], v[160:163]
    ds_read_b64_tr_b16 v[68:69], v193 offset:8192
    ds_read_b64_tr_b16 v[70:71], v193 offset:12288
    s_waitcnt lgkmcnt(10)
    v_mfma_f32_16x16x32_bf16 v[164:167], v[80:83], v[144:147], v[164:167]
    s_waitcnt lgkmcnt(8)
    v_mfma_f32_16x16x32_bf16 v[168:171], v[84:87], v[144:147], v[168:171]
    s_waitcnt lgkmcnt(6)
    v_mfma_f32_16x16x32_bf16 v[172:175], v[88:91], v[144:147], v[172:175]
    s_waitcnt lgkmcnt(4)
    v_mfma_f32_16x16x32_bf16 v[176:179], v[92:95], v[144:147], v[176:179]
    s_waitcnt lgkmcnt(2)
    v_mfma_f32_16x16x32_bf16 v[148:151], v[64:67], v[144:147], v[148:151]
    s_waitcnt lgkmcnt(0)
    v_mfma_f32_16x16x32_bf16 v[152:155], v[68:71], v[144:147], v[152:155]
    s_branch L_epi
L_last1:
    s_barrier
    ds_read_b128 v[32:35], v188 offset:16384
    ds_read_b128 v[36:39], v189 offset:16384
    ds_read_b128 v[40:43], v190 offset:16384
    ds_read_b128 v[44:47], v191 offset:16384
    ds_read_b128 v[48:51], v188 offset:20480
    ds_read_b128 v[52:55], v189 offset:20480
    ds_read_b128 v[56:59], v190 offset:20480
    ds_read_b128 v[60:63], v191 offset:20480
    ds_read_b64 v[208:209], v207 offset:8
    v_max3_f32 v203, v128, v129, v130
    v_max3_f32 v204, v131, v132, v133
    v_max3_f32 v203, v203, v134, v135
    v_max_f32 v203, v203, v204
    v_cmp_gt_f32 vcc, v203, v202
    s_cbranch_vccnz L_rarep1

L_retp1:
    v_fma_f32 v128, v128, s37, -v201
    v_fma_f32 v129, v129, s37, -v201
    v_fma_f32 v130, v130, s37, -v201
    v_fma_f32 v131, v131, s37, -v201
    v_fma_f32 v132, v132, s37, -v201
    v_fma_f32 v133, v133, s37, -v201
    v_fma_f32 v134, v134, s37, -v201
    v_fma_f32 v135, v135, s37, -v201
    v_exp_f32 v128, v128
    v_exp_f32 v129, v129
    v_exp_f32 v130, v130
    v_exp_f32 v131, v131
    v_exp_f32 v132, v132
    v_exp_f32 v133, v133
    v_exp_f32 v134, v134
    v_exp_f32 v135, v135
    v_cvt_pk_bf16_f32 v144, v128, v129
    v_cvt_pk_bf16_f32 v145, v130, v131
    v_cvt_pk_bf16_f32 v146, v132, v133
    v_cvt_pk_bf16_f32 v147, v134, v135
    s_nop 1
    v_mfma_f32_16x16x32_bf16 v[180:183], v[184:187], v[144:147], v[180:183]
    v_mfma_f32_16x16x32_bf16 v[148:151], v[64:67], v[144:147], v[148:151]
    v_mfma_f32_16x16x32_bf16 v[152:155], v[68:71], v[144:147], v[152:155]
    v_mfma_f32_16x16x32_bf16 v[156:159], v[72:75], v[144:147], v[156:159]
    v_mfma_f32_16x16x32_bf16 v[160:163], v[76:79], v[144:147], v[160:163]
    s_waitcnt lgkmcnt(0)
    v_mfma_f32_16x16x32_bf16 v[136:139], v[32:35], v[16:19], 0
    v_mfma_f32_16x16x32_bf16 v[140:143], v[48:51], v[16:19], 0
    v_mfma_f32_16x16x32_bf16 v[136:139], v[36:39], v[20:23], v[136:139]
    v_mfma_f32_16x16x32_bf16 v[140:143], v[52:55], v[20:23], v[140:143]
    v_mfma_f32_16x16x32_bf16 v[136:139], v[40:43], v[24:27], v[136:139]
    v_mfma_f32_16x16x32_bf16 v[140:143], v[56:59], v[24:27], v[140:143]
    v_mfma_f32_16x16x32_bf16 v[136:139], v[44:47], v[28:31], v[136:139]
    v_mfma_f32_16x16x32_bf16 v[140:143], v[60:63], v[28:31], v[140:143]
    v_mfma_f32_16x16x32_bf16 v[164:167], v[80:83], v[144:147], v[164:167]
    v_mfma_f32_16x16x32_bf16 v[168:171], v[84:87], v[144:147], v[168:171]
    v_mfma_f32_16x16x32_bf16 v[172:175], v[88:91], v[144:147], v[172:175]
    v_mfma_f32_16x16x32_bf16 v[176:179], v[92:95], v[144:147], v[176:179]
    s_nop 3
    v_max3_f32 v203, v136, v137, v138
    v_max3_f32 v204, v139, v140, v141
    v_max3_f32 v203, v203, v142, v143
    v_max_f32 v203, v203, v204
    v_cmp_gt_f32 vcc, v203, v202
    s_cbranch_vccnz L_rarec1

L_retc1:
    v_fma_f32 v136, v136, s37, -v201
    v_fma_f32 v137, v137, s37, -v201
    v_fma_f32 v138, v138, s37, -v201
    v_fma_f32 v139, v139, s37, -v201
    v_fma_f32 v140, v140, s37, -v201
    v_fma_f32 v141, v141, s37, -v201
    v_fma_f32 v142, v142, s37, -v201
    v_fma_f32 v143, v143, s37, -v201
    v_exp_f32 v136, v136
    v_exp_f32 v137, v137
    v_exp_f32 v138, v138
    v_exp_f32 v139, v139
    v_exp_f32 v140, v140
    v_exp_f32 v141, v141
    v_exp_f32 v142, v142
    v_exp_f32 v143, v143
    v_cvt_pk_bf16_f32 v144, v136, v137
    v_cvt_pk_bf16_f32 v145, v138, v139
    v_cvt_pk_bf16_f32 v146, v140, v141
    v_cvt_pk_bf16_f32 v147, v142, v143
    s_barrier
    ds_read_b64_tr_b16 v[104:105], v194 offset:24576
    ds_read_b64_tr_b16 v[106:107], v194 offset:28672
    ds_read_b64_tr_b16 v[108:109], v195 offset:24576
    ds_read_b64_tr_b16 v[110:111], v195 offset:28672
    ds_read_b64_tr_b16 v[112:113], v196 offset:24576
    ds_read_b64_tr_b16 v[114:115], v196 offset:28672
    ds_read_b64_tr_b16 v[116:117], v197 offset:24576
    ds_read_b64_tr_b16 v[118:119], v197 offset:28672
    ds_read_b64_tr_b16 v[120:121], v198 offset:24576
    ds_read_b64_tr_b16 v[122:123], v198 offset:28672
    ds_read_b64_tr_b16 v[124:125], v199 offset:24576
    ds_read_b64_tr_b16 v[126:127], v199 offset:28672
    v_mfma_f32_16x16x32_bf16 v[180:183], v[184:187], v[144:147], v[180:183]
    s_waitcnt lgkmcnt(10)
    v_mfma_f32_16x16x32_bf16 v[156:159], v[104:107], v[144:147], v[156:159]
    ds_read_b64_tr_b16 v[96:97], v192 offset:24576
    ds_read_b64_tr_b16 v[98:99], v192 offset:28672
    s_waitcnt lgkmcnt(10)
    v_mfma_f32_16x16x32_bf16 v[160:163], v[108:111], v[144:147], v[160:163]
    ds_read_b64_tr_b16 v[100:101], v193 offset:24576
    ds_read_b64_tr_b16 v[102:103], v193 offset:28672
    s_waitcnt lgkmcnt(10)
    v_mfma_f32_16x16x32_bf16 v[164:167], v[112:115], v[144:147], v[164:167]
    s_waitcnt lgkmcnt(8)
    v_mfma_f32_16x16x32_bf16 v[168:171], v[116:119], v[144:147], v[168:171]
    s_waitcnt lgkmcnt(6)
    v_mfma_f32_16x16x32_bf16 v[172:175], v[120:123], v[144:147], v[172:175]
    s_waitcnt lgkmcnt(4)
    v_mfma_f32_16x16x32_bf16 v[176:179], v[124:127], v[144:147], v[176:179]
    s_waitcnt lgkmcnt(2)
    v_mfma_f32_16x16x32_bf16 v[148:151], v[96:99], v[144:147], v[148:151]
    s_waitcnt lgkmcnt(0)
    v_mfma_f32_16x16x32_bf16 v[152:155], v[100:103], v[144:147], v[152:155]
    s_branch L_epi
L_last2:
    s_barrier
    ds_read_b128 v[32:35], v188 offset:32768
    ds_read_b128 v[36:39], v189 offset:32768
    ds_read_b128 v[40:43], v190 offset:32768
    ds_read_b128 v[44:47], v191 offset:32768
    ds_read_b128 v[48:51], v188 offset:36864
    ds_read_b128 v[52:55], v189 offset:36864
    ds_read_b128 v[56:59], v190 offset:36864
    ds_read_b128 v[60:63], v191 offset:36864
    ds_read_b64 v[208:209], v207 offset:8
    v_max3_f32 v203, v136, v137, v138
    v_max3_f32 v204, v139, v140, v141
    v_max3_f32 v203, v203, v142, v143
    v_max_f32 v203, v203, v204
    v_cmp_gt_f32 vcc, v203, v202
    s_cbranch_vccnz L_rarep2

L_retp2:
    v_fma_f32 v136, v136, s37, -v201
    v_fma_f32 v137, v137, s37, -v201
    v_fma_f32 v138, v138, s37, -v201
    v_fma_f32 v139, v139, s37, -v201
    v_fma_f32 v140, v140, s37, -v201
    v_fma_f32 v141, v141, s37, -v201
    v_fma_f32 v142, v142, s37, -v201
    v_fma_f32 v143, v143, s37, -v201
    v_exp_f32 v136, v136
    v_exp_f32 v137, v137
    v_exp_f32 v138, v138
    v_exp_f32 v139, v139
    v_exp_f32 v140, v140
    v_exp_f32 v141, v141
    v_exp_f32 v142, v142
    v_exp_f32 v143, v143
    v_cvt_pk_bf16_f32 v144, v136, v137
    v_cvt_pk_bf16_f32 v145, v138, v139
    v_cvt_pk_bf16_f32 v146, v140, v141
    v_cvt_pk_bf16_f32 v147, v142, v143
    s_nop 1
    v_mfma_f32_16x16x32_bf16 v[180:183], v[184:187], v[144:147], v[180:183]
    v_mfma_f32_16x16x32_bf16 v[148:151], v[96:99], v[144:147], v[148:151]
    v_mfma_f32_16x16x32_bf16 v[152:155], v[100:103], v[144:147], v[152:155]
    v_mfma_f32_16x16x32_bf16 v[156:159], v[104:107], v[144:147], v[156:159]
    v_mfma_f32_16x16x32_bf16 v[160:163], v[108:111], v[144:147], v[160:163]
    s_waitcnt lgkmcnt(0)
    v_mfma_f32_16x16x32_bf16 v[128:131], v[32:35], v[16:19], 0
    v_mfma_f32_16x16x32_bf16 v[132:135], v[48:51], v[16:19], 0
    v_mfma_f32_16x16x32_bf16 v[128:131], v[36:39], v[20:23], v[128:131]
    v_mfma_f32_16x16x32_bf16 v[132:135], v[52:55], v[20:23], v[132:135]
    v_mfma_f32_16x16x32_bf16 v[128:131], v[40:43], v[24:27], v[128:131]
    v_mfma_f32_16x16x32_bf16 v[132:135], v[56:59], v[24:27], v[132:135]
    v_mfma_f32_16x16x32_bf16 v[128:131], v[44:47], v[28:31], v[128:131]
    v_mfma_f32_16x16x32_bf16 v[132:135], v[60:63], v[28:31], v[132:135]
    v_mfma_f32_16x16x32_bf16 v[164:167], v[112:115], v[144:147], v[164:167]
    v_mfma_f32_16x16x32_bf16 v[168:171], v[116:119], v[144:147], v[168:171]
    v_mfma_f32_16x16x32_bf16 v[172:175], v[120:123], v[144:147], v[172:175]
    v_mfma_f32_16x16x32_bf16 v[176:179], v[124:127], v[144:147], v[176:179]
    s_nop 3
    v_max3_f32 v203, v128, v129, v130
    v_max3_f32 v204, v131, v132, v133
    v_max3_f32 v203, v203, v134, v135
    v_max_f32 v203, v203, v204
    v_cmp_gt_f32 vcc, v203, v202
    s_cbranch_vccnz L_rarec2

L_retc2:
    v_fma_f32 v128, v128, s37, -v201
    v_fma_f32 v129, v129, s37, -v201
    v_fma_f32 v130, v130, s37, -v201
    v_fma_f32 v131, v131, s37, -v201
    v_fma_f32 v132, v132, s37, -v201
    v_fma_f32 v133, v133, s37, -v201
    v_fma_f32 v134, v134, s37, -v201
    v_fma_f32 v135, v135, s37, -v201
    v_exp_f32 v128, v128
    v_exp_f32 v129, v129
    v_exp_f32 v130, v130
    v_exp_f32 v131, v131
    v_exp_f32 v132, v132
    v_exp_f32 v133, v133
    v_exp_f32 v134, v134
    v_exp_f32 v135, v135
    v_cvt_pk_bf16_f32 v144, v128, v129
    v_cvt_pk_bf16_f32 v145, v130, v131
    v_cvt_pk_bf16_f32 v146, v132, v133
    v_cvt_pk_bf16_f32 v147, v134, v135
    s_barrier
    ds_read_b64_tr_b16 v[72:73], v194 offset:40960
    ds_read_b64_tr_b16 v[74:75], v194 offset:45056
    ds_read_b64_tr_b16 v[76:77], v195 offset:40960
    ds_read_b64_tr_b16 v[78:79], v195 offset:45056
    ds_read_b64_tr_b16 v[80:81], v196 offset:40960
    ds_read_b64_tr_b16 v[82:83], v196 offset:45056
    ds_read_b64_tr_b16 v[84:85], v197 offset:40960
    ds_read_b64_tr_b16 v[86:87], v197 offset:45056
    ds_read_b64_tr_b16 v[88:89], v198 offset:40960
    ds_read_b64_tr_b16 v[90:91], v198 offset:45056
    ds_read_b64_tr_b16 v[92:93], v199 offset:40960
    ds_read_b64_tr_b16 v[94:95], v199 offset:45056
    v_mfma_f32_16x16x32_bf16 v[180:183], v[184:187], v[144:147], v[180:183]
    s_waitcnt lgkmcnt(10)
    v_mfma_f32_16x16x32_bf16 v[156:159], v[72:75], v[144:147], v[156:159]
    ds_read_b64_tr_b16 v[64:65], v192 offset:40960
    ds_read_b64_tr_b16 v[66:67], v192 offset:45056
    s_waitcnt lgkmcnt(10)
    v_mfma_f32_16x16x32_bf16 v[160:163], v[76:79], v[144:147], v[160:163]
    ds_read_b64_tr_b16 v[68:69], v193 offset:40960
    ds_read_b64_tr_b16 v[70:71], v193 offset:45056
    s_waitcnt lgkmcnt(10)
    v_mfma_f32_16x16x32_bf16 v[164:167], v[80:83], v[144:147], v[164:167]
    s_waitcnt lgkmcnt(8)
    v_mfma_f32_16x16x32_bf16 v[168:171], v[84:87], v[144:147], v[168:171]
    s_waitcnt lgkmcnt(6)
    v_mfma_f32_16x16x32_bf16 v[172:175], v[88:91], v[144:147], v[172:175]
    s_waitcnt lgkmcnt(4)
    v_mfma_f32_16x16x32_bf16 v[176:179], v[92:95], v[144:147], v[176:179]
    s_waitcnt lgkmcnt(2)
    v_mfma_f32_16x16x32_bf16 v[148:151], v[64:67], v[144:147], v[148:151]
    s_waitcnt lgkmcnt(0)
    v_mfma_f32_16x16x32_bf16 v[152:155], v[68:71], v[144:147], v[152:155]
    s_branch L_epi
L_last3:
    s_barrier
    ds_read_b128 v[32:35], v188 offset:49152
    ds_read_b128 v[36:39], v189 offset:49152
    ds_read_b128 v[40:43], v190 offset:49152
    ds_read_b128 v[44:47], v191 offset:49152
    ds_read_b128 v[48:51], v188 offset:53248
    ds_read_b128 v[52:55], v189 offset:53248
    ds_read_b128 v[56:59], v190 offset:53248
    ds_read_b128 v[60:63], v191 offset:53248
    ds_read_b64 v[208:209], v207 offset:8
    v_max3_f32 v203, v128, v129, v130
    v_max3_f32 v204, v131, v132, v133
    v_max3_f32 v203, v203, v134, v135
    v_max_f32 v203, v203, v204
    v_cmp_gt_f32 vcc, v203, v202
    s_cbranch_vccnz L_rarep3

L_retp3:
    v_fma_f32 v128, v128, s37, -v201
    v_fma_f32 v129, v129, s37, -v201
    v_fma_f32 v130, v130, s37, -v201
    v_fma_f32 v131, v131, s37, -v201
    v_fma_f32 v132, v132, s37, -v201
    v_fma_f32 v133, v133, s37, -v201
    v_fma_f32 v134, v134, s37, -v201
    v_fma_f32 v135, v135, s37, -v201
    v_exp_f32 v128, v128
    v_exp_f32 v129, v129
    v_exp_f32 v130, v130
    v_exp_f32 v131, v131
    v_exp_f32 v132, v132
    v_exp_f32 v133, v133
    v_exp_f32 v134, v134
    v_exp_f32 v135, v135
    v_cvt_pk_bf16_f32 v144, v128, v129
    v_cvt_pk_bf16_f32 v145, v130, v131
    v_cvt_pk_bf16_f32 v146, v132, v133
    v_cvt_pk_bf16_f32 v147, v134, v135
    s_nop 1
    v_mfma_f32_16x16x32_bf16 v[180:183], v[184:187], v[144:147], v[180:183]
    v_mfma_f32_16x16x32_bf16 v[148:151], v[64:67], v[144:147], v[148:151]
    v_mfma_f32_16x16x32_bf16 v[152:155], v[68:71], v[144:147], v[152:155]
    v_mfma_f32_16x16x32_bf16 v[156:159], v[72:75], v[144:147], v[156:159]
    v_mfma_f32_16x16x32_bf16 v[160:163], v[76:79], v[144:147], v[160:163]
    s_waitcnt lgkmcnt(0)
    v_mfma_f32_16x16x32_bf16 v[136:139], v[32:35], v[16:19], 0
    v_mfma_f32_16x16x32_bf16 v[140:143], v[48:51], v[16:19], 0
    v_mfma_f32_16x16x32_bf16 v[136:139], v[36:39], v[20:23], v[136:139]
    v_mfma_f32_16x16x32_bf16 v[140:143], v[52:55], v[20:23], v[140:143]
    v_mfma_f32_16x16x32_bf16 v[136:139], v[40:43], v[24:27], v[136:139]
    v_mfma_f32_16x16x32_bf16 v[140:143], v[56:59], v[24:27], v[140:143]
    v_mfma_f32_16x16x32_bf16 v[136:139], v[44:47], v[28:31], v[136:139]
    v_mfma_f32_16x16x32_bf16 v[140:143], v[60:63], v[28:31], v[140:143]
    v_mfma_f32_16x16x32_bf16 v[164:167], v[80:83], v[144:147], v[164:167]
    v_mfma_f32_16x16x32_bf16 v[168:171], v[84:87], v[144:147], v[168:171]
    v_mfma_f32_16x16x32_bf16 v[172:175], v[88:91], v[144:147], v[172:175]
    v_mfma_f32_16x16x32_bf16 v[176:179], v[92:95], v[144:147], v[176:179]
    s_nop 3
    v_max3_f32 v203, v136, v137, v138
    v_max3_f32 v204, v139, v140, v141
    v_max3_f32 v203, v203, v142, v143
    v_max_f32 v203, v203, v204
    v_cmp_gt_f32 vcc, v203, v202
    s_cbranch_vccnz L_rarec3

L_retc3:
    v_fma_f32 v136, v136, s37, -v201
    v_fma_f32 v137, v137, s37, -v201
    v_fma_f32 v138, v138, s37, -v201
    v_fma_f32 v139, v139, s37, -v201
    v_fma_f32 v140, v140, s37, -v201
    v_fma_f32 v141, v141, s37, -v201
    v_fma_f32 v142, v142, s37, -v201
    v_fma_f32 v143, v143, s37, -v201
    v_exp_f32 v136, v136
    v_exp_f32 v137, v137
    v_exp_f32 v138, v138
    v_exp_f32 v139, v139
    v_exp_f32 v140, v140
    v_exp_f32 v141, v141
    v_exp_f32 v142, v142
    v_exp_f32 v143, v143
    v_cvt_pk_bf16_f32 v144, v136, v137
    v_cvt_pk_bf16_f32 v145, v138, v139
    v_cvt_pk_bf16_f32 v146, v140, v141
    v_cvt_pk_bf16_f32 v147, v142, v143
    s_barrier
    ds_read_b64_tr_b16 v[104:105], v194 offset:57344
    ds_read_b64_tr_b16 v[106:107], v194 offset:61440
    ds_read_b64_tr_b16 v[108:109], v195 offset:57344
    ds_read_b64_tr_b16 v[110:111], v195 offset:61440
    ds_read_b64_tr_b16 v[112:113], v196 offset:57344
    ds_read_b64_tr_b16 v[114:115], v196 offset:61440
    ds_read_b64_tr_b16 v[116:117], v197 offset:57344
    ds_read_b64_tr_b16 v[118:119], v197 offset:61440
    ds_read_b64_tr_b16 v[120:121], v198 offset:57344
    ds_read_b64_tr_b16 v[122:123], v198 offset:61440
    ds_read_b64_tr_b16 v[124:125], v199 offset:57344
    ds_read_b64_tr_b16 v[126:127], v199 offset:61440
    v_mfma_f32_16x16x32_bf16 v[180:183], v[184:187], v[144:147], v[180:183]
    s_waitcnt lgkmcnt(10)
    v_mfma_f32_16x16x32_bf16 v[156:159], v[104:107], v[144:147], v[156:159]
    ds_read_b64_tr_b16 v[96:97], v192 offset:57344
    ds_read_b64_tr_b16 v[98:99], v192 offset:61440
    s_waitcnt lgkmcnt(10)
    v_mfma_f32_16x16x32_bf16 v[160:163], v[108:111], v[144:147], v[160:163]
    ds_read_b64_tr_b16 v[100:101], v193 offset:57344
    ds_read_b64_tr_b16 v[102:103], v193 offset:61440
    s_waitcnt lgkmcnt(10)
    v_mfma_f32_16x16x32_bf16 v[164:167], v[112:115], v[144:147], v[164:167]
    s_waitcnt lgkmcnt(8)
    v_mfma_f32_16x16x32_bf16 v[168:171], v[116:119], v[144:147], v[168:171]
    s_waitcnt lgkmcnt(6)
    v_mfma_f32_16x16x32_bf16 v[172:175], v[120:123], v[144:147], v[172:175]
    s_waitcnt lgkmcnt(4)
    v_mfma_f32_16x16x32_bf16 v[176:179], v[124:127], v[144:147], v[176:179]
    s_waitcnt lgkmcnt(2)
    v_mfma_f32_16x16x32_bf16 v[148:151], v[96:99], v[144:147], v[148:151]
    s_waitcnt lgkmcnt(0)
    v_mfma_f32_16x16x32_bf16 v[152:155], v[100:103], v[144:147], v[152:155]
    s_branch L_epi
L_rare0:
    v_max_f32 v203, v203, v200
    v_mov_b32 v204, v203
    s_nop 1
    v_permlane16_swap_b32 v203, v204
    v_max_f32 v203, v203, v204
    v_mov_b32 v204, v203
    s_nop 1
    v_permlane32_swap_b32 v203, v204
    v_max_f32 v200, v203, v204
    v_mul_f32 v205, s37, v200
    v_add_f32 v202, s44, v200
    v_sub_f32 v206, v201, v205
    v_exp_f32 v206, v206
    v_mov_b32 v201, v205
    s_nop 0

    v_mul_f32 v180, v206, v180
    v_mul_f32 v181, v206, v181
    v_mul_f32 v182, v206, v182
    v_mul_f32 v183, v206, v183
    v_mul_f32 v148, v206, v148
    v_mul_f32 v149, v206, v149
    v_mul_f32 v150, v206, v150
    v_mul_f32 v151, v206, v151
    v_mul_f32 v152, v206, v152
    v_mul_f32 v153, v206, v153
    v_mul_f32 v154, v206, v154
    v_mul_f32 v155, v206, v155
    v_mul_f32 v156, v206, v156
    v_mul_f32 v157, v206, v157
    v_mul_f32 v158, v206, v158
    v_mul_f32 v159, v206, v159
    v_mul_f32 v160, v206, v160
    v_mul_f32 v161, v206, v161
    v_mul_f32 v162, v206, v162
    v_mul_f32 v163, v206, v163
    v_mul_f32 v164, v206, v164
    v_mul_f32 v165, v206, v165
    v_mul_f32 v166, v206, v166
    v_mul_f32 v167, v206, v167
    v_mul_f32 v168, v206, v168
    v_mul_f32 v169, v206, v169
    v_mul_f32 v170, v206, v170
    v_mul_f32 v171, v206, v171
    v_mul_f32 v172, v206, v172
    v_mul_f32 v173, v206, v173
    v_mul_f32 v174, v206, v174
    v_mul_f32 v175, v206, v175
    v_mul_f32 v176, v206, v176
    v_mul_f32 v177, v206, v177
    v_mul_f32 v178, v206, v178
    v_mul_f32 v179, v206, v179
    s_branch L_ret0
L_rare1:
    v_max_f32 v203, v203, v200
    v_mov_b32 v204, v203
    s_nop 1
    v_permlane16_swap_b32 v203, v204
    v_max_f32 v203, v203, v204
    v_mov_b32 v204, v203
    s_nop 1
    v_permlane32_swap_b32 v203, v204
    v_max_f32 v200, v203, v204
    v_mul_f32 v205, s37, v200
    v_add_f32 v202, s44, v200
    v_sub_f32 v206, v201, v205
    v_exp_f32 v206, v206
    v_mov_b32 v201, v205
    s_nop 0

    v_mul_f32 v180, v206, v180
    v_mul_f32 v181, v206, v181
    v_mul_f32 v182, v206, v182
    v_mul_f32 v183, v206, v183
    v_mul_f32 v148, v206, v148
    v_mul_f32 v149, v206, v149
    v_mul_f32 v150, v206, v150
    v_mul_f32 v151, v206, v151
    v_mul_f32 v152, v206, v152
    v_mul_f32 v153, v206, v153
    v_mul_f32 v154, v206, v154
    v_mul_f32 v155, v206, v155
    v_mul_f32 v156, v206, v156
    v_mul_f32 v157, v206, v157
    v_mul_f32 v158, v206, v158
    v_mul_f32 v159, v206, v159
    v_mul_f32 v160, v206, v160
    v_mul_f32 v161, v206, v161
    v_mul_f32 v162, v206, v162
    v_mul_f32 v163, v206, v163
    v_mul_f32 v164, v206, v164
    v_mul_f32 v165, v206, v165
    v_mul_f32 v166, v206, v166
    v_mul_f32 v167, v206, v167
    v_mul_f32 v168, v206, v168
    v_mul_f32 v169, v206, v169
    v_mul_f32 v170, v206, v170
    v_mul_f32 v171, v206, v171
    v_mul_f32 v172, v206, v172
    v_mul_f32 v173, v206, v173
    v_mul_f32 v174, v206, v174
    v_mul_f32 v175, v206, v175
    v_mul_f32 v176, v206, v176
    v_mul_f32 v177, v206, v177
    v_mul_f32 v178, v206, v178
    v_mul_f32 v179, v206, v179
    s_branch L_ret1
L_rare2:
    v_max_f32 v203, v203, v200
    v_mov_b32 v204, v203
    s_nop 1
    v_permlane16_swap_b32 v203, v204
    v_max_f32 v203, v203, v204
    v_mov_b32 v204, v203
    s_nop 1
    v_permlane32_swap_b32 v203, v204
    v_max_f32 v200, v203, v204
    v_mul_f32 v205, s37, v200
    v_add_f32 v202, s44, v200
    v_sub_f32 v206, v201, v205
    v_exp_f32 v206, v206
    v_mov_b32 v201, v205
    s_nop 0

    v_mul_f32 v180, v206, v180
    v_mul_f32 v181, v206, v181
    v_mul_f32 v182, v206, v182
    v_mul_f32 v183, v206, v183
    v_mul_f32 v148, v206, v148
    v_mul_f32 v149, v206, v149
    v_mul_f32 v150, v206, v150
    v_mul_f32 v151, v206, v151
    v_mul_f32 v152, v206, v152
    v_mul_f32 v153, v206, v153
    v_mul_f32 v154, v206, v154
    v_mul_f32 v155, v206, v155
    v_mul_f32 v156, v206, v156
    v_mul_f32 v157, v206, v157
    v_mul_f32 v158, v206, v158
    v_mul_f32 v159, v206, v159
    v_mul_f32 v160, v206, v160
    v_mul_f32 v161, v206, v161
    v_mul_f32 v162, v206, v162
    v_mul_f32 v163, v206, v163
    v_mul_f32 v164, v206, v164
    v_mul_f32 v165, v206, v165
    v_mul_f32 v166, v206, v166
    v_mul_f32 v167, v206, v167
    v_mul_f32 v168, v206, v168
    v_mul_f32 v169, v206, v169
    v_mul_f32 v170, v206, v170
    v_mul_f32 v171, v206, v171
    v_mul_f32 v172, v206, v172
    v_mul_f32 v173, v206, v173
    v_mul_f32 v174, v206, v174
    v_mul_f32 v175, v206, v175
    v_mul_f32 v176, v206, v176
    v_mul_f32 v177, v206, v177
    v_mul_f32 v178, v206, v178
    v_mul_f32 v179, v206, v179
    s_branch L_ret2
L_rare3:
    v_max_f32 v203, v203, v200
    v_mov_b32 v204, v203
    s_nop 1
    v_permlane16_swap_b32 v203, v204
    v_max_f32 v203, v203, v204
    v_mov_b32 v204, v203
    s_nop 1
    v_permlane32_swap_b32 v203, v204
    v_max_f32 v200, v203, v204
    v_mul_f32 v205, s37, v200
    v_add_f32 v202, s44, v200
    v_sub_f32 v206, v201, v205
    v_exp_f32 v206, v206
    v_mov_b32 v201, v205
    s_nop 0

    v_mul_f32 v180, v206, v180
    v_mul_f32 v181, v206, v181
    v_mul_f32 v182, v206, v182
    v_mul_f32 v183, v206, v183
    v_mul_f32 v148, v206, v148
    v_mul_f32 v149, v206, v149
    v_mul_f32 v150, v206, v150
    v_mul_f32 v151, v206, v151
    v_mul_f32 v152, v206, v152
    v_mul_f32 v153, v206, v153
    v_mul_f32 v154, v206, v154
    v_mul_f32 v155, v206, v155
    v_mul_f32 v156, v206, v156
    v_mul_f32 v157, v206, v157
    v_mul_f32 v158, v206, v158
    v_mul_f32 v159, v206, v159
    v_mul_f32 v160, v206, v160
    v_mul_f32 v161, v206, v161
    v_mul_f32 v162, v206, v162
    v_mul_f32 v163, v206, v163
    v_mul_f32 v164, v206, v164
    v_mul_f32 v165, v206, v165
    v_mul_f32 v166, v206, v166
    v_mul_f32 v167, v206, v167
    v_mul_f32 v168, v206, v168
    v_mul_f32 v169, v206, v169
    v_mul_f32 v170, v206, v170
    v_mul_f32 v171, v206, v171
    v_mul_f32 v172, v206, v172
    v_mul_f32 v173, v206, v173
    v_mul_f32 v174, v206, v174
    v_mul_f32 v175, v206, v175
    v_mul_f32 v176, v206, v176
    v_mul_f32 v177, v206, v177
    v_mul_f32 v178, v206, v178
    v_mul_f32 v179, v206, v179
    s_branch L_ret3
L_rarep0:
    v_max_f32 v203, v203, v200
    v_mov_b32 v204, v203
    s_nop 1
    v_permlane16_swap_b32 v203, v204
    v_max_f32 v203, v203, v204
    v_mov_b32 v204, v203
    s_nop 1
    v_permlane32_swap_b32 v203, v204
    v_max_f32 v200, v203, v204
    v_mul_f32 v205, s37, v200
    v_add_f32 v202, s44, v200
    v_sub_f32 v206, v201, v205
    v_exp_f32 v206, v206
    v_mov_b32 v201, v205
    s_nop 0

    v_mul_f32 v180, v206, v180
    v_mul_f32 v181, v206, v181
    v_mul_f32 v182, v206, v182
    v_mul_f32 v183, v206, v183
    v_mul_f32 v148, v206, v148
    v_mul_f32 v149, v206, v149
    v_mul_f32 v150, v206, v150
    v_mul_f32 v151, v206, v151
    v_mul_f32 v152, v206, v152
    v_mul_f32 v153, v206, v153
    v_mul_f32 v154, v206, v154
    v_mul_f32 v155, v206, v155
    v_mul_f32 v156, v206, v156
    v_mul_f32 v157, v206, v157
    v_mul_f32 v158, v206, v158
    v_mul_f32 v159, v206, v159
    v_mul_f32 v160, v206, v160
    v_mul_f32 v161, v206, v161
    v_mul_f32 v162, v206, v162
    v_mul_f32 v163, v206, v163
    v_mul_f32 v164, v206, v164
    v_mul_f32 v165, v206, v165
    v_mul_f32 v166, v206, v166
    v_mul_f32 v167, v206, v167
    v_mul_f32 v168, v206, v168
    v_mul_f32 v169, v206, v169
    v_mul_f32 v170, v206, v170
    v_mul_f32 v171, v206, v171
    v_mul_f32 v172, v206, v172
    v_mul_f32 v173, v206, v173
    v_mul_f32 v174, v206, v174
    v_mul_f32 v175, v206, v175
    v_mul_f32 v176, v206, v176
    v_mul_f32 v177, v206, v177
    v_mul_f32 v178, v206, v178
    v_mul_f32 v179, v206, v179
    s_branch L_retp0
L_rarec0:
    v_max_f32 v203, v203, v200
    v_mov_b32 v204, v203
    s_nop 1
    v_permlane16_swap_b32 v203, v204
    v_max_f32 v203, v203, v204
    v_mov_b32 v204, v203
    s_nop 1
    v_permlane32_swap_b32 v203, v204
    v_max_f32 v200, v203, v204
    v_mul_f32 v205, s37, v200
    v_add_f32 v202, s44, v200
    v_sub_f32 v206, v201, v205
    v_exp_f32 v206, v206
    v_mov_b32 v201, v205
    s_nop 0

    v_mul_f32 v180, v206, v180
    v_mul_f32 v181, v206, v181
    v_mul_f32 v182, v206, v182
    v_mul_f32 v183, v206, v183
    v_mul_f32 v148, v206, v148
    v_mul_f32 v149, v206, v149
    v_mul_f32 v150, v206, v150
    v_mul_f32 v151, v206, v151
    v_mul_f32 v152, v206, v152
    v_mul_f32 v153, v206, v153
    v_mul_f32 v154, v206, v154
    v_mul_f32 v155, v206, v155
    v_mul_f32 v156, v206, v156
    v_mul_f32 v157, v206, v157
    v_mul_f32 v158, v206, v158
    v_mul_f32 v159, v206, v159
    v_mul_f32 v160, v206, v160
    v_mul_f32 v161, v206, v161
    v_mul_f32 v162, v206, v162
    v_mul_f32 v163, v206, v163
    v_mul_f32 v164, v206, v164
    v_mul_f32 v165, v206, v165
    v_mul_f32 v166, v206, v166
    v_mul_f32 v167, v206, v167
    v_mul_f32 v168, v206, v168
    v_mul_f32 v169, v206, v169
    v_mul_f32 v170, v206, v170
    v_mul_f32 v171, v206, v171
    v_mul_f32 v172, v206, v172
    v_mul_f32 v173, v206, v173
    v_mul_f32 v174, v206, v174
    v_mul_f32 v175, v206, v175
    v_mul_f32 v176, v206, v176
    v_mul_f32 v177, v206, v177
    v_mul_f32 v178, v206, v178
    v_mul_f32 v179, v206, v179
    s_branch L_retc0
L_rarep1:
    v_max_f32 v203, v203, v200
    v_mov_b32 v204, v203
    s_nop 1
    v_permlane16_swap_b32 v203, v204
    v_max_f32 v203, v203, v204
    v_mov_b32 v204, v203
    s_nop 1
    v_permlane32_swap_b32 v203, v204
    v_max_f32 v200, v203, v204
    v_mul_f32 v205, s37, v200
    v_add_f32 v202, s44, v200
    v_sub_f32 v206, v201, v205
    v_exp_f32 v206, v206
    v_mov_b32 v201, v205
    s_nop 0

    v_mul_f32 v180, v206, v180
    v_mul_f32 v181, v206, v181
    v_mul_f32 v182, v206, v182
    v_mul_f32 v183, v206, v183
    v_mul_f32 v148, v206, v148
    v_mul_f32 v149, v206, v149
    v_mul_f32 v150, v206, v150
    v_mul_f32 v151, v206, v151
    v_mul_f32 v152, v206, v152
    v_mul_f32 v153, v206, v153
    v_mul_f32 v154, v206, v154
    v_mul_f32 v155, v206, v155
    v_mul_f32 v156, v206, v156
    v_mul_f32 v157, v206, v157
    v_mul_f32 v158, v206, v158
    v_mul_f32 v159, v206, v159
    v_mul_f32 v160, v206, v160
    v_mul_f32 v161, v206, v161
    v_mul_f32 v162, v206, v162
    v_mul_f32 v163, v206, v163
    v_mul_f32 v164, v206, v164
    v_mul_f32 v165, v206, v165
    v_mul_f32 v166, v206, v166
    v_mul_f32 v167, v206, v167
    v_mul_f32 v168, v206, v168
    v_mul_f32 v169, v206, v169
    v_mul_f32 v170, v206, v170
    v_mul_f32 v171, v206, v171
    v_mul_f32 v172, v206, v172
    v_mul_f32 v173, v206, v173
    v_mul_f32 v174, v206, v174
    v_mul_f32 v175, v206, v175
    v_mul_f32 v176, v206, v176
    v_mul_f32 v177, v206, v177
    v_mul_f32 v178, v206, v178
    v_mul_f32 v179, v206, v179
    s_branch L_retp1
L_rarec1:
    v_max_f32 v203, v203, v200
    v_mov_b32 v204, v203
    s_nop 1
    v_permlane16_swap_b32 v203, v204
    v_max_f32 v203, v203, v204
    v_mov_b32 v204, v203
    s_nop 1
    v_permlane32_swap_b32 v203, v204
    v_max_f32 v200, v203, v204
    v_mul_f32 v205, s37, v200
    v_add_f32 v202, s44, v200
    v_sub_f32 v206, v201, v205
    v_exp_f32 v206, v206
    v_mov_b32 v201, v205
    s_nop 0

    v_mul_f32 v180, v206, v180
    v_mul_f32 v181, v206, v181
    v_mul_f32 v182, v206, v182
    v_mul_f32 v183, v206, v183
    v_mul_f32 v148, v206, v148
    v_mul_f32 v149, v206, v149
    v_mul_f32 v150, v206, v150
    v_mul_f32 v151, v206, v151
    v_mul_f32 v152, v206, v152
    v_mul_f32 v153, v206, v153
    v_mul_f32 v154, v206, v154
    v_mul_f32 v155, v206, v155
    v_mul_f32 v156, v206, v156
    v_mul_f32 v157, v206, v157
    v_mul_f32 v158, v206, v158
    v_mul_f32 v159, v206, v159
    v_mul_f32 v160, v206, v160
    v_mul_f32 v161, v206, v161
    v_mul_f32 v162, v206, v162
    v_mul_f32 v163, v206, v163
    v_mul_f32 v164, v206, v164
    v_mul_f32 v165, v206, v165
    v_mul_f32 v166, v206, v166
    v_mul_f32 v167, v206, v167
    v_mul_f32 v168, v206, v168
    v_mul_f32 v169, v206, v169
    v_mul_f32 v170, v206, v170
    v_mul_f32 v171, v206, v171
    v_mul_f32 v172, v206, v172
    v_mul_f32 v173, v206, v173
    v_mul_f32 v174, v206, v174
    v_mul_f32 v175, v206, v175
    v_mul_f32 v176, v206, v176
    v_mul_f32 v177, v206, v177
    v_mul_f32 v178, v206, v178
    v_mul_f32 v179, v206, v179
    s_branch L_retc1
L_rarep2:
    v_max_f32 v203, v203, v200
    v_mov_b32 v204, v203
    s_nop 1
    v_permlane16_swap_b32 v203, v204
    v_max_f32 v203, v203, v204
    v_mov_b32 v204, v203
    s_nop 1
    v_permlane32_swap_b32 v203, v204
    v_max_f32 v200, v203, v204
    v_mul_f32 v205, s37, v200
    v_add_f32 v202, s44, v200
    v_sub_f32 v206, v201, v205
    v_exp_f32 v206, v206
    v_mov_b32 v201, v205
    s_nop 0

    v_mul_f32 v180, v206, v180
    v_mul_f32 v181, v206, v181
    v_mul_f32 v182, v206, v182
    v_mul_f32 v183, v206, v183
    v_mul_f32 v148, v206, v148
    v_mul_f32 v149, v206, v149
    v_mul_f32 v150, v206, v150
    v_mul_f32 v151, v206, v151
    v_mul_f32 v152, v206, v152
    v_mul_f32 v153, v206, v153
    v_mul_f32 v154, v206, v154
    v_mul_f32 v155, v206, v155
    v_mul_f32 v156, v206, v156
    v_mul_f32 v157, v206, v157
    v_mul_f32 v158, v206, v158
    v_mul_f32 v159, v206, v159
    v_mul_f32 v160, v206, v160
    v_mul_f32 v161, v206, v161
    v_mul_f32 v162, v206, v162
    v_mul_f32 v163, v206, v163
    v_mul_f32 v164, v206, v164
    v_mul_f32 v165, v206, v165
    v_mul_f32 v166, v206, v166
    v_mul_f32 v167, v206, v167
    v_mul_f32 v168, v206, v168
    v_mul_f32 v169, v206, v169
    v_mul_f32 v170, v206, v170
    v_mul_f32 v171, v206, v171
    v_mul_f32 v172, v206, v172
    v_mul_f32 v173, v206, v173
    v_mul_f32 v174, v206, v174
    v_mul_f32 v175, v206, v175
    v_mul_f32 v176, v206, v176
    v_mul_f32 v177, v206, v177
    v_mul_f32 v178, v206, v178
    v_mul_f32 v179, v206, v179
    s_branch L_retp2
L_rarec2:
    v_max_f32 v203, v203, v200
    v_mov_b32 v204, v203
    s_nop 1
    v_permlane16_swap_b32 v203, v204
    v_max_f32 v203, v203, v204
    v_mov_b32 v204, v203
    s_nop 1
    v_permlane32_swap_b32 v203, v204
    v_max_f32 v200, v203, v204
    v_mul_f32 v205, s37, v200
    v_add_f32 v202, s44, v200
    v_sub_f32 v206, v201, v205
    v_exp_f32 v206, v206
    v_mov_b32 v201, v205
    s_nop 0

    v_mul_f32 v180, v206, v180
    v_mul_f32 v181, v206, v181
    v_mul_f32 v182, v206, v182
    v_mul_f32 v183, v206, v183
    v_mul_f32 v148, v206, v148
    v_mul_f32 v149, v206, v149
    v_mul_f32 v150, v206, v150
    v_mul_f32 v151, v206, v151
    v_mul_f32 v152, v206, v152
    v_mul_f32 v153, v206, v153
    v_mul_f32 v154, v206, v154
    v_mul_f32 v155, v206, v155
    v_mul_f32 v156, v206, v156
    v_mul_f32 v157, v206, v157
    v_mul_f32 v158, v206, v158
    v_mul_f32 v159, v206, v159
    v_mul_f32 v160, v206, v160
    v_mul_f32 v161, v206, v161
    v_mul_f32 v162, v206, v162
    v_mul_f32 v163, v206, v163
    v_mul_f32 v164, v206, v164
    v_mul_f32 v165, v206, v165
    v_mul_f32 v166, v206, v166
    v_mul_f32 v167, v206, v167
    v_mul_f32 v168, v206, v168
    v_mul_f32 v169, v206, v169
    v_mul_f32 v170, v206, v170
    v_mul_f32 v171, v206, v171
    v_mul_f32 v172, v206, v172
    v_mul_f32 v173, v206, v173
    v_mul_f32 v174, v206, v174
    v_mul_f32 v175, v206, v175
    v_mul_f32 v176, v206, v176
    v_mul_f32 v177, v206, v177
    v_mul_f32 v178, v206, v178
    v_mul_f32 v179, v206, v179
    s_branch L_retc2
L_rarep3:
    v_max_f32 v203, v203, v200
    v_mov_b32 v204, v203
    s_nop 1
    v_permlane16_swap_b32 v203, v204
    v_max_f32 v203, v203, v204
    v_mov_b32 v204, v203
    s_nop 1
    v_permlane32_swap_b32 v203, v204
    v_max_f32 v200, v203, v204
    v_mul_f32 v205, s37, v200
    v_add_f32 v202, s44, v200
    v_sub_f32 v206, v201, v205
    v_exp_f32 v206, v206
    v_mov_b32 v201, v205
    s_nop 0

    v_mul_f32 v180, v206, v180
    v_mul_f32 v181, v206, v181
    v_mul_f32 v182, v206, v182
    v_mul_f32 v183, v206, v183
    v_mul_f32 v148, v206, v148
    v_mul_f32 v149, v206, v149
    v_mul_f32 v150, v206, v150
    v_mul_f32 v151, v206, v151
    v_mul_f32 v152, v206, v152
    v_mul_f32 v153, v206, v153
    v_mul_f32 v154, v206, v154
    v_mul_f32 v155, v206, v155
    v_mul_f32 v156, v206, v156
    v_mul_f32 v157, v206, v157
    v_mul_f32 v158, v206, v158
    v_mul_f32 v159, v206, v159
    v_mul_f32 v160, v206, v160
    v_mul_f32 v161, v206, v161
    v_mul_f32 v162, v206, v162
    v_mul_f32 v163, v206, v163
    v_mul_f32 v164, v206, v164
    v_mul_f32 v165, v206, v165
    v_mul_f32 v166, v206, v166
    v_mul_f32 v167, v206, v167
    v_mul_f32 v168, v206, v168
    v_mul_f32 v169, v206, v169
    v_mul_f32 v170, v206, v170
    v_mul_f32 v171, v206, v171
    v_mul_f32 v172, v206, v172
    v_mul_f32 v173, v206, v173
    v_mul_f32 v174, v206, v174
    v_mul_f32 v175, v206, v175
    v_mul_f32 v176, v206, v176
    v_mul_f32 v177, v206, v177
    v_mul_f32 v178, v206, v178
    v_mul_f32 v179, v206, v179
    s_branch L_retp3
L_rarec3:
    v_max_f32 v203, v203, v200
    v_mov_b32 v204, v203
    s_nop 1
    v_permlane16_swap_b32 v203, v204
    v_max_f32 v203, v203, v204
    v_mov_b32 v204, v203
    s_nop 1
    v_permlane32_swap_b32 v203, v204
    v_max_f32 v200, v203, v204
    v_mul_f32 v205, s37, v200
    v_add_f32 v202, s44, v200
    v_sub_f32 v206, v201, v205
    v_exp_f32 v206, v206
    v_mov_b32 v201, v205
    s_nop 0

    v_mul_f32 v180, v206, v180
    v_mul_f32 v181, v206, v181
    v_mul_f32 v182, v206, v182
    v_mul_f32 v183, v206, v183
    v_mul_f32 v148, v206, v148
    v_mul_f32 v149, v206, v149
    v_mul_f32 v150, v206, v150
    v_mul_f32 v151, v206, v151
    v_mul_f32 v152, v206, v152
    v_mul_f32 v153, v206, v153
    v_mul_f32 v154, v206, v154
    v_mul_f32 v155, v206, v155
    v_mul_f32 v156, v206, v156
    v_mul_f32 v157, v206, v157
    v_mul_f32 v158, v206, v158
    v_mul_f32 v159, v206, v159
    v_mul_f32 v160, v206, v160
    v_mul_f32 v161, v206, v161
    v_mul_f32 v162, v206, v162
    v_mul_f32 v163, v206, v163
    v_mul_f32 v164, v206, v164
    v_mul_f32 v165, v206, v165
    v_mul_f32 v166, v206, v166
    v_mul_f32 v167, v206, v167
    v_mul_f32 v168, v206, v168
    v_mul_f32 v169, v206, v169
    v_mul_f32 v170, v206, v170
    v_mul_f32 v171, v206, v171
    v_mul_f32 v172, v206, v172
    v_mul_f32 v173, v206, v173
    v_mul_f32 v174, v206, v174
    v_mul_f32 v175, v206, v175
    v_mul_f32 v176, v206, v176
    v_mul_f32 v177, v206, v177
    v_mul_f32 v178, v206, v178
    v_mul_f32 v179, v206, v179
    s_branch L_retc3
L_epi:
    v_mov_b32 v84, 0
    v_mov_b32 v85, 0
    s_nop 4
    v_max3_f32 v203, |v156|, |v157|, |v158|
    v_max3_f32 v204, |v159|, |v160|, |v161|
    v_max3_f32 v203, v203, |v162|, |v163|
    v_max3_f32 v204, v204, |v164|, |v165|
    v_max3_f32 v203, v203, |v166|, |v167|
    v_max3_f32 v204, v204, |v168|, |v169|
    v_max3_f32 v203, v203, |v170|, |v171|
    v_max3_f32 v204, v204, |v172|, |v173|
    v_max3_f32 v203, v203, |v174|, |v175|
    v_max3_f32 v204, v204, |v176|, |v177|
    v_max3_f32 v203, v203, |v178|, |v179|
    v_max_f32 v203, v203, v204
    v_mov_b32 v56, v201
    v_mov_b32 v204, v203
    v_mov_b32 v57, v180
    s_nop 0
    v_permlane16_swap_b32 v203, v204
    v_max_f32 v203, v203, v204
    v_mov_b32 v204, v203
    v_mov_b32 v59, 0
    s_nop 0
    v_permlane32_swap_b32 v203, v204
    v_max_f32 v203, v203, v204
    v_frexp_exp_i32_f32 v204, v203
    v_sub_u32 v204, 15, v204
    v_min_i32 v58, 0x7e, v204
    v_ldexp_f32 v12, 1.0, v58

    s_mov_b64 exec, 0xffff
    global_store_dwordx4 v217, v[56:59], s[40:41] sc1
    s_mov_b64 exec, -1
    s_waitcnt lgkmcnt(0)
    v_dot2_u32_u16 v60, v56, s80, v209
    v_dot2_u32_u16 v60, v57, s81, v60
    v_dot2_u32_u16 v60, v58, s82, v60

    v_pk_mul_f32 v[156:157], v[156:157], v[12:13] op_sel_hi:[1,0]
    v_pk_mul_f32 v[158:159], v[158:159], v[12:13] op_sel_hi:[1,0]
    v_pk_mul_f32 v[160:161], v[160:161], v[12:13] op_sel_hi:[1,0]
    v_pk_mul_f32 v[162:163], v[162:163], v[12:13] op_sel_hi:[1,0]
    v_cvt_pk_f16_f32 v44, v156, v157
    v_cvt_pk_f16_f32 v45, v158, v159
    v_cvt_pk_f16_f32 v46, v160, v161
    v_cvt_pk_f16_f32 v47, v162, v163
    global_store_dwordx4 v210, v[44:47], s[40:41] sc1
    v_dot2_u32_u16 v61, v44, s76, v60
    v_dot2_u32_u16 v61, v45, s77, v61
    v_dot2_u32_u16 v61, v46, s78, v61
    v_dot2_u32_u16 v61, v47, s79, v61
    v_pk_mul_f32 v[164:165], v[164:165], v[12:13] op_sel_hi:[1,0]
    v_pk_mul_f32 v[166:167], v[166:167], v[12:13] op_sel_hi:[1,0]
    v_pk_mul_f32 v[168:169], v[168:169], v[12:13] op_sel_hi:[1,0]
    v_pk_mul_f32 v[170:171], v[170:171], v[12:13] op_sel_hi:[1,0]
    v_cvt_pk_f16_f32 v48, v164, v165
    v_cvt_pk_f16_f32 v49, v166, v167
    v_cvt_pk_f16_f32 v50, v168, v169
    v_cvt_pk_f16_f32 v51, v170, v171
    global_store_dwordx4 v211, v[48:51], s[40:41] sc1
    v_dot2_u32_u16 v62, v48, s76, v60
    v_dot2_u32_u16 v62, v49, s77, v62
    v_dot2_u32_u16 v62, v50, s78, v62
    v_dot2_u32_u16 v62, v51, s79, v62
    v_pk_mul_f32 v[172:173], v[172:173], v[12:13] op_sel_hi:[1,0]
    v_pk_mul_f32 v[174:175], v[174:175], v[12:13] op_sel_hi:[1,0]
    v_pk_mul_f32 v[176:177], v[176:177], v[12:13] op_sel_hi:[1,0]
    v_pk_mul_f32 v[178:179], v[178:179], v[12:13] op_sel_hi:[1,0]
    v_cvt_pk_f16_f32 v52, v172, v173
    v_cvt_pk_f16_f32 v53, v174, v175
    v_cvt_pk_f16_f32 v54, v176, v177
    v_cvt_pk_f16_f32 v55, v178, v179
    global_store_dwordx4 v212, v[52:55], s[40:41] sc1
    v_dot2_u32_u16 v63, v52, s76, v60
    v_dot2_u32_u16 v63, v53, s77, v63
    v_dot2_u32_u16 v63, v54, s78, v63
    v_dot2_u32_u16 v63, v55, s79, v63
    v_add_u32_dpp v61, v61, v61 quad_perm:[1,0,3,2] row_mask:0xf bank_mask:0xf
    v_add_u32_dpp v62, v62, v62 quad_perm:[1,0,3,2] row_mask:0xf bank_mask:0xf
    s_nop 0
    v_add_u32_dpp v63, v63, v63 quad_perm:[1,0,3,2] row_mask:0xf bank_mask:0xf
    v_add_u32_dpp v61, v61, v61 quad_perm:[2,3,0,1] row_mask:0xf bank_mask:0xf
    v_add_u32_dpp v62, v62, v62 quad_perm:[2,3,0,1] row_mask:0xf bank_mask:0xf
    v_add_u32_dpp v63, v63, v63 quad_perm:[2,3,0,1] row_mask:0xf bank_mask:0xf
    v_cndmask_b32 v14, v63, v62, s[86:87]
    v_mov_b32 v15, v208
    v_cndmask_b32 v14, v14, v61, s[84:85]
    s_mov_b64 exec, s[88:89]
    global_store_dwordx2 v221, v[14:15], s[40:41] sc1

    s_mov_b32 s46, 7
    s_mov_b32 s47, 0
    s_mov_b64 exec, s[46:47]
    s_mov_b32 s36, 65536

    s_branch L_poll0
L_poll:
    s_sleep 1
L_poll0:
    global_atomic_add_x2 v[76:77], v222, v[84:85], s[40:41] sc0
    s_sub_u32 s36, s36, 1
    s_cmp_eq_u32 s36, 0
    s_cbranch_scc1 L_poll_ok
    s_waitcnt vmcnt(0)
    v_cmp_eq_u32 vcc, v77, v208
    s_cmp_eq_u32 vcc_lo, s46
    s_cbranch_scc0 L_poll

L_poll_ok:
    s_mov_b64 exec, -1
L_reload:
    global_load_dwordx4 v[64:67], v218, s[40:41] sc1
    global_load_dwordx4 v[68:71], v219, s[40:41] sc1
    global_load_dwordx4 v[72:75], v220, s[40:41] sc1
    global_load_dwordx4 v[32:35], v213, s[40:41] sc1
    global_load_dwordx4 v[36:39], v214, s[40:41] sc1
    global_load_dwordx4 v[40:43], v215, s[40:41] sc1
    s_mov_b64 exec, s[88:89]
    global_load_dwordx2 v[86:87], v222, s[40:41] sc1
    s_mov_b64 exec, -1

    s_waitcnt vmcnt(4)
    v_dot2_u32_u16 v61, v64, s80, v209
    v_dot2_u32_u16 v62, v68, s80, v209
    v_dot2_u32_u16 v63, v72, s80, v209
    v_dot2_u32_u16 v61, v65, s81, v61
    v_dot2_u32_u16 v62, v69, s81, v62
    v_dot2_u32_u16 v63, v73, s81, v63
    v_dot2_u32_u16 v61, v66, s82, v61
    v_dot2_u32_u16 v62, v70, s82, v62
    v_dot2_u32_u16 v63, v74, s82, v63
    v_max3_f32 v203, v201, v64, v68
    v_max_f32 v203, v203, v72
    v_sub_f32 v12, v201, v203
    v_sub_f32 v13, v64, v203
    v_sub_f32 v14, v68, v203
    v_sub_f32 v15, v72, v203
    v_exp_f32 v12, v12
    v_exp_f32 v13, v13
    v_exp_f32 v14, v14
    v_exp_f32 v15, v15
    v_sub_u32 v66, 0, v66
    v_sub_u32 v70, 0, v70
    v_sub_u32 v74, 0, v74
    v_mul_f32 v204, v180, v12
    v_fmac_f32 v204, v65, v13
    v_fmac_f32 v204, v69, v14
    v_fmac_f32 v204, v73, v15
    v_rcp_f32 v206, v204
    v_ldexp_f32 v13, v13, v66
    v_ldexp_f32 v14, v14, v70
    v_ldexp_f32 v15, v15, v74

    v_mul_f32 v88, v148, v12
    v_mul_f32 v89, v149, v12
    v_mul_f32 v90, v150, v12
    v_mul_f32 v91, v151, v12
    v_mul_f32 v92, v152, v12
    v_mul_f32 v93, v153, v12
    v_mul_f32 v94, v154, v12
    v_mul_f32 v95, v155, v12
    v_fma_f32 v205, -v204, v206, 1.0
    v_fmac_f32 v206, v206, v205

    s_waitcnt vmcnt(0)
    v_dot2_u32_u16 v61, v32, s76, v61
    v_dot2_u32_u16 v62, v36, s76, v62
    v_dot2_u32_u16 v63, v40, s76, v63
    v_dot2_u32_u16 v61, v33, s77, v61
    v_dot2_u32_u16 v62, v37, s77, v62
    v_dot2_u32_u16 v63, v41, s77, v63
    v_dot2_u32_u16 v61, v34, s78, v61
    v_dot2_u32_u16 v62, v38, s78, v62
    v_dot2_u32_u16 v63, v42, s78, v63
    v_dot2_u32_u16 v61, v35, s79, v61
    v_dot2_u32_u16 v62, v39, s79, v62
    v_dot2_u32_u16 v63, v43, s79, v63
    v_fma_mix_f32 v88, v32, v13, v88 op_sel:[0,0,0] op_sel_hi:[1,0,0]
    v_fma_mix_f32 v89, v32, v13, v89 op_sel:[1,0,0] op_sel_hi:[1,0,0]
    v_fma_mix_f32 v90, v33, v13, v90 op_sel:[0,0,0] op_sel_hi:[1,0,0]
    v_fma_mix_f32 v91, v33, v13, v91 op_sel:[1,0,0] op_sel_hi:[1,0,0]
    v_fma_mix_f32 v92, v34, v13, v92 op_sel:[0,0,0] op_sel_hi:[1,0,0]
    v_fma_mix_f32 v93, v34, v13, v93 op_sel:[1,0,0] op_sel_hi:[1,0,0]
    v_fma_mix_f32 v94, v35, v13, v94 op_sel:[0,0,0] op_sel_hi:[1,0,0]
    v_fma_mix_f32 v95, v35, v13, v95 op_sel:[1,0,0] op_sel_hi:[1,0,0]
    v_add_u32_dpp v61, v61, v61 quad_perm:[1,0,3,2] row_mask:0xf bank_mask:0xf
    v_add_u32_dpp v62, v62, v62 quad_perm:[1,0,3,2] row_mask:0xf bank_mask:0xf
    v_add_u32_dpp v63, v63, v63 quad_perm:[1,0,3,2] row_mask:0xf bank_mask:0xf
    v_fma_mix_f32 v88, v36, v14, v88 op_sel:[0,0,0] op_sel_hi:[1,0,0]
    v_fma_mix_f32 v89, v36, v14, v89 op_sel:[1,0,0] op_sel_hi:[1,0,0]
    v_fma_mix_f32 v90, v37, v14, v90 op_sel:[0,0,0] op_sel_hi:[1,0,0]
    v_fma_mix_f32 v91, v37, v14, v91 op_sel:[1,0,0] op_sel_hi:[1,0,0]
    v_fma_mix_f32 v92, v38, v14, v92 op_sel:[0,0,0] op_sel_hi:[1,0,0]
    v_fma_mix_f32 v93, v38, v14, v93 op_sel:[1,0,0] op_sel_hi:[1,0,0]
    v_fma_mix_f32 v94, v39, v14, v94 op_sel:[0,0,0] op_sel_hi:[1,0,0]
    v_fma_mix_f32 v95, v39, v14, v95 op_sel:[1,0,0] op_sel_hi:[1,0,0]
    v_add_u32_dpp v61, v61, v61 quad_perm:[2,3,0,1] row_mask:0xf bank_mask:0xf
    v_add_u32_dpp v62, v62, v62 quad_perm:[2,3,0,1] row_mask:0xf bank_mask:0xf
    v_add_u32_dpp v63, v63, v63 quad_perm:[2,3,0,1] row_mask:0xf bank_mask:0xf
    v_fma_mix_f32 v88, v40, v15, v88 op_sel:[0,0,0] op_sel_hi:[1,0,0]
    v_fma_mix_f32 v89, v40, v15, v89 op_sel:[1,0,0] op_sel_hi:[1,0,0]
    v_fma_mix_f32 v90, v41, v15, v90 op_sel:[0,0,0] op_sel_hi:[1,0,0]
    v_fma_mix_f32 v91, v41, v15, v91 op_sel:[1,0,0] op_sel_hi:[1,0,0]
    v_fma_mix_f32 v92, v42, v15, v92 op_sel:[0,0,0] op_sel_hi:[1,0,0]
    v_fma_mix_f32 v93, v42, v15, v93 op_sel:[1,0,0] op_sel_hi:[1,0,0]
    v_fma_mix_f32 v94, v43, v15, v94 op_sel:[0,0,0] op_sel_hi:[1,0,0]
    v_fma_mix_f32 v95, v43, v15, v95 op_sel:[1,0,0] op_sel_hi:[1,0,0]
    v_cndmask_b32 v203, v63, v62, s[86:87]
    v_cndmask_b32 v203, v203, v61, s[84:85]
    v_cmp_ne_u32 vcc, v203, v86
    s_and_b64 vcc, vcc, s[88:89]
    s_cbranch_scc0 L_verified
    s_sub_u32 s90, s90, 1
    s_cmp_eq_u32 s90, 0
    s_cbranch_scc0 L_reload

L_verified:
    v_mul_f32 v148, v88, v206
    v_mul_f32 v149, v89, v206
    v_mul_f32 v150, v90, v206
    v_mul_f32 v151, v91, v206
    v_mul_f32 v152, v92, v206
    v_mul_f32 v153, v93, v206
    v_mul_f32 v154, v94, v206
    v_mul_f32 v155, v95, v206
    v_cvt_pk_bf16_f32 v12, v148, v149
    v_cvt_pk_bf16_f32 v13, v150, v151
    v_cvt_pk_bf16_f32 v14, v152, v153
    v_cvt_pk_bf16_f32 v15, v154, v155
    global_store_dwordx2 v216, v[12:13], s[10:11]
    global_store_dwordx2 v216, v[14:15], s[10:11] offset:32

L_done:
    s_endpgm
.section .rodata,"a"
.p2align 6
.amdhsa_kernel standalone__gqa_softmax__sampling_kernel
  .amdhsa_next_free_vgpr 224
  .amdhsa_next_free_sgpr 102
  .amdhsa_accum_offset 224
  .amdhsa_group_segment_fixed_size 0
  .amdhsa_kernarg_size 48
  .amdhsa_user_sgpr_count 2
  .amdhsa_user_sgpr_kernarg_segment_ptr 1
  .amdhsa_system_sgpr_workgroup_id_x 1
.end_amdhsa_kernel
```
